```python
import torch

def _softmax(x, axis=-1):
    return torch.softmax(x, dim=axis)

def _gelu(x):
    return torch.nn.functional.gelu(x, approximate='tanh')

def _silu(x):
    return torch.nn.functional.silu(x)

def _sigmoid(x):
    return torch.sigmoid(x)

def _layernorm(x, axis=-1, eps=1e-05):
    m = x.mean(dim=axis, keepdim=True)
    v = x.var(dim=axis, keepdim=True, unbiased=False)
    return (x - m) / torch.sqrt(v + eps)

def _scatter_add(tgt, idx, src, axis=0):
    return tgt.clone().index_add_(axis, idx, src)

def _segment_sum(src, seg, n):
    out = torch.zeros((n,) + src.shape[1:], dtype=src.dtype)
    return out.index_add_(0, seg, src)

def _pad(x, pw):
    flat = tuple((v for pair in reversed(pw) for v in pair))
    return torch.nn.functional.pad(x, flat)
kernel_name = 'adaLN_cond__ssm_conv_s4__dense_activation_squared_relu__prompt'

def setup_inputs():

    _w = lambda a: (lambda t: t.to(torch.bfloat16) if t.is_floating_point() else t)(torch.as_tensor(a))

    def _A_setup():
        B, L, D, N = (1, 2048, 512, 128)
        A_re = -(lambda _x: torch.exp(torch.as_tensor(_x)))((lambda *s: torch.randn(*s, dtype=torch.bfloat16) * 12.8)(D, N))
        A_im = torch.pi * (lambda *s: torch.randn(*s, dtype=torch.bfloat16) * 0.1)(D, N)
        B_re = (lambda *s: torch.randn(*s, dtype=torch.bfloat16) * 0.2)(D, N)
        B_im = (lambda *s: torch.randn(*s, dtype=torch.bfloat16) * 0.2)(D, N)
        C_re = (lambda *s: torch.randn(*s, dtype=torch.bfloat16) * 0.2)(D, N)
        C_im = (lambda *s: torch.randn(*s, dtype=torch.bfloat16) * 0.2)(D, N)
        log_dt = (lambda *s: torch.randn(*s, dtype=torch.bfloat16) * 0.1)(D) * 0.5 - 4.0
        Dskip = (lambda *s: torch.randn(*s, dtype=torch.bfloat16) * 0.1)(D)
        return {'u': _w((lambda *s: torch.randn(*s, dtype=torch.bfloat16) * 0.05)(B, L, D)), 'A_re': _w(A_re), 'A_im': _w(A_im), 'B_re': _w(B_re), 'B_im': _w(B_im), 'C_re': _w(C_re), 'C_im': _w(C_im), 'log_dt': _w(log_dt), 'Dskip': _w(Dskip)}
    _A_in = _A_setup()

    def _B_setup():
        B, S, D, F = (1, 2048, 512, 1792)
        return {'x': _w((lambda *s: torch.randn(*s, dtype=torch.bfloat16) * 0.05)(B, S, D)), 'w1': _w((lambda *s: torch.randn(*s, dtype=torch.bfloat16) * 0.05)(D, F)), 'b1': _w((lambda *s: torch.randn(*s, dtype=torch.bfloat16) * 1.6)(F)), 'w2': _w((lambda *s: torch.randn(*s, dtype=torch.bfloat16) * 0.05)(F, D)), 'b2': _w((lambda *s: torch.randn(*s, dtype=torch.bfloat16) * 12.8)(D))}
    _B_in = _B_setup()
    return {'A_u': _A_in['u'], 'A_A_re': _A_in['A_re'], 'A_A_im': _A_in['A_im'], 'A_B_re': _A_in['B_re'], 'A_B_im': _A_in['B_im'], 'A_C_re': _A_in['C_re'], 'A_C_im': _A_in['C_im'], 'A_log_dt': _A_in['log_dt'], 'A_Dskip': _A_in['Dskip'], 'B_x': _B_in['x'], 'B_w1': _B_in['w1'], 'B_b1': _B_in['b1'], 'B_w2': _B_in['w2'], 'B_b2': _B_in['b2'], 'c': _w((lambda *s: torch.randn(*s, dtype=torch.bfloat16) * 0.2)(1, 512) * 8.0), 'w_mod': _w((lambda *s: torch.randn(*s, dtype=torch.bfloat16) * 0.2)(512, 6 * 512) * 512 ** (-0.5) * 8.0)}

def reference(A_u, A_A_re, A_A_im, A_B_re, A_B_im, A_C_re, A_C_im, A_log_dt, A_Dskip, B_x, B_w1, B_b1, B_w2, B_b2, c, w_mod):

    def _A_ref(u, A_re, A_im, B_re, B_im, C_re, C_im, log_dt, Dskip):
        Bsz, L, D = u.shape
        dt = torch.exp(log_dt)[:, None]
        A = A_re + 1j * A_im
        Bc = B_re + 1j * B_im
        Cc = C_re + 1j * C_im
        logdA = dt * A
        dB = dt * Bc
        l = (lambda x, dt: x.to(dt))(torch.arange(L), A_re.dtype)
        P = torch.exp(logdA[:, :, None] * l[None, None, :])
        K = torch.einsum('dn,dnl,dn->dl', Cc, P, dB).real
        L2 = 2 * L
        Kp = _pad(K, ((0, 0), (0, L)))
        up = (lambda x, *d: x.permute(*d))(u, 0, 2, 1)
        up = _pad(up, ((0, 0), (0, 0), (0, L)))
        Kf = (lambda x, axes=(-2, -1): torch.fft.rfft2(x.float(), dim=axes))(Kp[:, None, :], axes=(-2, -1))
        Uf = (lambda x, axes=(-2, -1): torch.fft.rfft2(x.float(), dim=axes))(up[:, :, None, :], axes=(-2, -1))
        Yf = Uf * Kf[None, :, :, :]
        y = (lambda x, s, axes=(-2, -1): torch.fft.irfft2(x, s=s, dim=axes).to(torch.bfloat16))(Yf, (1, L2), axes=(-2, -1))[:, :, 0, :L]
        y = (lambda x, *d: x.permute(*d))(y, 0, 2, 1) + u * Dskip[None, None, :]
        return y

    def _B_ref(x, w1, b1, w2, b2):
        h = torch.einsum('bsd,df->bsf', x, w1) + b1
        zero = torch.zeros_like(h)
        r = torch.where(h > zero, h, zero)
        h = r * r
        out = torch.einsum('bsf,fd->bsd', h, w2) + b2
        return out
    x = A_u
    mod = (_silu(c) @ w_mod).reshape(c.shape[0], 6, 1, -1)
    sa, ca, ga, sb, cb, gb = (mod[:, 0].clone(), mod[:, 1].clone(), mod[:, 2].clone(), mod[:, 3].clone(), mod[:, 4].clone(), mod[:, 5].clone())
    h = _layernorm(x, axis=-1) * (1 + ca) + sa
    x = x + ga * _A_ref(h, A_A_re, A_A_im, A_B_re, A_B_im, A_C_re, A_C_im, A_log_dt, A_Dskip)
    h = _layernorm(x, axis=-1) * (1 + cb) + sb
    x = x + gb * _B_ref(h, B_w1, B_b1, B_w2, B_b2)
    return x
```

```asm
; @launch kernel=k1_kernel grid=(832,1,1) block=(256,1,1) lds=36864
; @launch kernel=k2_kernel grid=(432,1,1) block=(256,1,1) lds=59392
; @launch kernel=k3_kernel grid=(256,1,1) block=(512,1,1) lds=68608
.amdgcn_target "amdgcn-amd-amdhsa--gfx950"
.text
.globl k1_kernel
.p2align 8
.type k1_kernel,@function
k1_kernel:
    s_cmp_ge_u32 s2, 832
    s_cbranch_scc1 K1_END
    v_and_b32 v1, 63, v0
    v_lshrrev_b32 v2, 6, v0

    s_mov_b32 s3, 512
    s_cmp_ge_u32 s2, 128
    s_cselect_b32 s3, -128, s3
    s_cmp_ge_u32 s2, 384
    s_cselect_b32 s3, 256, s3
    s_cmp_ge_u32 s2, 480
    s_cselect_b32 s3, -224, s3
    s_cmp_ge_u32 s2, 736
    s_cselect_b32 s3, 0, s3
    s_add_u32 s2, s2, s3
    s_mov_b32 s3, s2
    s_cmp_lt_u32 s2, 512
    s_cbranch_scc1 K1_KG
    s_sub_u32 s2, s2, 512

    s_cmp_ge_u32 s2, 320
    s_cbranch_scc1 K1_W2
    s_cmp_ge_u32 s2, 128
    s_cbranch_scc1 K1_MOD
K1_LN:

    s_load_dwordx2 s[4:5], s[0:1], 0
    s_load_dwordx2 s[8:9], s[0:1], 144
    s_waitcnt lgkmcnt(0)
    s_and_b32 s5, s5, 0xffff
    s_mov_b32 s6, 0x200000
    s_mov_b32 s7, 0x00020000
    s_add_u32 s8, s8, 0x1800000
    s_addc_u32 s9, s9, 0
    s_and_b32 s9, s9, 0xffff
    s_mov_b32 s10, 0x410000
    s_mov_b32 s11, 0x00020000
    s_lshl_b32 s3, s2, 14
    v_lshlrev_b32 v3, 12, v2
    v_lshl_add_u32 v3, v1, 4, v3

    buffer_load_dwordx4 v[4:7], v3, s[4:7], s3 offen offset:0
    buffer_load_dwordx4 v[8:11], v3, s[4:7], s3 offen offset:1024
    buffer_load_dwordx4 v[12:15], v3, s[4:7], s3 offen offset:2048
    buffer_load_dwordx4 v[16:19], v3, s[4:7], s3 offen offset:3072
    s_lshl_b32 s16, s2, 7
    v_mul_u32_u24 v3, 576, v1
    v_lshl_add_u32 v3, v2, 5, v3
    s_mov_b32 s17, 0xffff0000
    v_lshrrev_b32 v80, 3, v0
    v_mov_b32 v84, 0x3f803f80
    v_mov_b32 v36, 0
    v_mov_b32 v37, 0
    v_mov_b32 v38, 0
    v_mov_b32 v39, 0
    v_mov_b32 v72, 0
    v_mov_b32 v73, 0
    v_mov_b32 v74, 0
    v_mov_b32 v75, 0
    v_and_b32 v81, 7, v0
    v_mul_u32_u24 v82, 144, v80
    v_lshl_add_u32 v82, v81, 4, v82
    v_mul_u32_u24 v83, 16640, v80
    v_lshl_add_u32 v83, v81, 4, v83
    s_waitcnt vmcnt(0)

    v_dot2c_f32_bf16 v36, v4, v84
    v_dot2c_f32_bf16 v72, v4, v4
    v_dot2c_f32_bf16 v37, v8, v84
    v_dot2c_f32_bf16 v73, v8, v8
    v_dot2c_f32_bf16 v38, v12, v84
    v_dot2c_f32_bf16 v74, v12, v12
    v_dot2c_f32_bf16 v39, v16, v84
    v_dot2c_f32_bf16 v75, v16, v16
    v_dot2c_f32_bf16 v36, v5, v84
    v_dot2c_f32_bf16 v72, v5, v5
    v_dot2c_f32_bf16 v37, v9, v84
    v_dot2c_f32_bf16 v73, v9, v9
    v_dot2c_f32_bf16 v38, v13, v84
    v_dot2c_f32_bf16 v74, v13, v13
    v_dot2c_f32_bf16 v39, v17, v84
    v_dot2c_f32_bf16 v75, v17, v17
    v_dot2c_f32_bf16 v36, v6, v84
    v_dot2c_f32_bf16 v72, v6, v6
    v_dot2c_f32_bf16 v37, v10, v84
    v_dot2c_f32_bf16 v73, v10, v10
    v_dot2c_f32_bf16 v38, v14, v84
    v_dot2c_f32_bf16 v74, v14, v14
    v_dot2c_f32_bf16 v39, v18, v84
    v_dot2c_f32_bf16 v75, v18, v18
    v_dot2c_f32_bf16 v36, v7, v84
    v_dot2c_f32_bf16 v72, v7, v7
    v_dot2c_f32_bf16 v37, v11, v84
    v_dot2c_f32_bf16 v73, v11, v11
    v_dot2c_f32_bf16 v38, v15, v84
    v_dot2c_f32_bf16 v74, v15, v15
    v_dot2c_f32_bf16 v39, v19, v84
    v_dot2c_f32_bf16 v75, v19, v19
    v_lshlrev_b32 v40, 16, v4
    v_and_b32 v41, s17, v4
    v_lshlrev_b32 v42, 16, v5
    v_and_b32 v43, s17, v5
    v_lshlrev_b32 v44, 16, v6
    v_and_b32 v45, s17, v6
    v_lshlrev_b32 v46, 16, v7
    v_and_b32 v47, s17, v7
    v_lshlrev_b32 v48, 16, v8
    v_and_b32 v49, s17, v8
    v_lshlrev_b32 v50, 16, v9
    v_and_b32 v51, s17, v9
    v_lshlrev_b32 v52, 16, v10
    v_and_b32 v53, s17, v10
    v_lshlrev_b32 v54, 16, v11
    v_and_b32 v55, s17, v11
    v_lshlrev_b32 v56, 16, v12
    v_and_b32 v57, s17, v12
    v_lshlrev_b32 v58, 16, v13
    v_and_b32 v59, s17, v13
    v_lshlrev_b32 v60, 16, v14
    v_and_b32 v61, s17, v14
    v_lshlrev_b32 v62, 16, v15
    v_and_b32 v63, s17, v15
    v_lshlrev_b32 v64, 16, v16
    v_and_b32 v65, s17, v16
    v_lshlrev_b32 v66, 16, v17
    v_and_b32 v67, s17, v17
    v_lshlrev_b32 v68, 16, v18
    v_and_b32 v69, s17, v18
    v_lshlrev_b32 v70, 16, v19
    v_and_b32 v71, s17, v19
    v_add_f32_dpp v36, v36, v36 row_ror:8 row_mask:0xf bank_mask:0xf
    v_add_f32_dpp v37, v37, v37 row_ror:8 row_mask:0xf bank_mask:0xf
    v_add_f32_dpp v38, v38, v38 row_ror:8 row_mask:0xf bank_mask:0xf
    v_add_f32_dpp v39, v39, v39 row_ror:8 row_mask:0xf bank_mask:0xf
    v_add_f32_dpp v72, v72, v72 row_ror:8 row_mask:0xf bank_mask:0xf
    v_add_f32_dpp v73, v73, v73 row_ror:8 row_mask:0xf bank_mask:0xf
    v_add_f32_dpp v74, v74, v74 row_ror:8 row_mask:0xf bank_mask:0xf
    v_add_f32_dpp v75, v75, v75 row_ror:8 row_mask:0xf bank_mask:0xf
    v_add_f32_dpp v36, v36, v36 row_ror:4 row_mask:0xf bank_mask:0xf
    v_add_f32_dpp v37, v37, v37 row_ror:4 row_mask:0xf bank_mask:0xf
    v_add_f32_dpp v38, v38, v38 row_ror:4 row_mask:0xf bank_mask:0xf
    v_add_f32_dpp v39, v39, v39 row_ror:4 row_mask:0xf bank_mask:0xf
    v_add_f32_dpp v72, v72, v72 row_ror:4 row_mask:0xf bank_mask:0xf
    v_add_f32_dpp v73, v73, v73 row_ror:4 row_mask:0xf bank_mask:0xf
    v_add_f32_dpp v74, v74, v74 row_ror:4 row_mask:0xf bank_mask:0xf
    v_add_f32_dpp v75, v75, v75 row_ror:4 row_mask:0xf bank_mask:0xf
    v_add_f32_dpp v36, v36, v36 row_ror:2 row_mask:0xf bank_mask:0xf
    v_add_f32_dpp v37, v37, v37 row_ror:2 row_mask:0xf bank_mask:0xf
    v_add_f32_dpp v38, v38, v38 row_ror:2 row_mask:0xf bank_mask:0xf
    v_add_f32_dpp v39, v39, v39 row_ror:2 row_mask:0xf bank_mask:0xf
    v_add_f32_dpp v72, v72, v72 row_ror:2 row_mask:0xf bank_mask:0xf
    v_add_f32_dpp v73, v73, v73 row_ror:2 row_mask:0xf bank_mask:0xf
    v_add_f32_dpp v74, v74, v74 row_ror:2 row_mask:0xf bank_mask:0xf
    v_add_f32_dpp v75, v75, v75 row_ror:2 row_mask:0xf bank_mask:0xf
    v_add_f32_dpp v36, v36, v36 row_ror:1 row_mask:0xf bank_mask:0xf
    v_add_f32_dpp v37, v37, v37 row_ror:1 row_mask:0xf bank_mask:0xf
    v_add_f32_dpp v38, v38, v38 row_ror:1 row_mask:0xf bank_mask:0xf
    v_add_f32_dpp v39, v39, v39 row_ror:1 row_mask:0xf bank_mask:0xf
    v_add_f32_dpp v72, v72, v72 row_ror:1 row_mask:0xf bank_mask:0xf
    v_add_f32_dpp v73, v73, v73 row_ror:1 row_mask:0xf bank_mask:0xf
    v_add_f32_dpp v74, v74, v74 row_ror:1 row_mask:0xf bank_mask:0xf
    v_add_f32_dpp v75, v75, v75 row_ror:1 row_mask:0xf bank_mask:0xf
    s_nop 1
    v_readlane_b32 s20, v36, 0
    v_readlane_b32 s21, v36, 16
    v_readlane_b32 s22, v36, 32
    v_readlane_b32 s23, v36, 48
    v_readlane_b32 s24, v37, 0
    v_readlane_b32 s25, v37, 16
    v_readlane_b32 s26, v37, 32
    v_readlane_b32 s27, v37, 48
    v_readlane_b32 s28, v38, 0
    v_readlane_b32 s29, v38, 16
    v_readlane_b32 s30, v38, 32
    v_readlane_b32 s31, v38, 48
    v_readlane_b32 s32, v39, 0
    v_readlane_b32 s33, v39, 16
    v_readlane_b32 s34, v39, 32
    v_readlane_b32 s35, v39, 48
    v_readlane_b32 s36, v72, 0
    v_readlane_b32 s37, v72, 16
    v_readlane_b32 s38, v72, 32
    v_readlane_b32 s39, v72, 48
    v_readlane_b32 s40, v73, 0
    v_readlane_b32 s41, v73, 16
    v_readlane_b32 s42, v73, 32
    v_readlane_b32 s43, v73, 48
    v_readlane_b32 s44, v74, 0
    v_readlane_b32 s45, v74, 16
    v_readlane_b32 s46, v74, 32
    v_readlane_b32 s47, v74, 48
    v_readlane_b32 s48, v75, 0
    v_readlane_b32 s49, v75, 16
    v_readlane_b32 s50, v75, 32
    v_readlane_b32 s51, v75, 48
    s_nop 1
    v_mov_b32 v36, s20
    v_add_f32 v36, s21, v36
    v_add_f32 v36, s22, v36
    v_add_f32 v36, s23, v36
    v_mov_b32 v37, s24
    v_add_f32 v37, s25, v37
    v_add_f32 v37, s26, v37
    v_add_f32 v37, s27, v37
    v_mov_b32 v38, s28
    v_add_f32 v38, s29, v38
    v_add_f32 v38, s30, v38
    v_add_f32 v38, s31, v38
    v_mov_b32 v39, s32
    v_add_f32 v39, s33, v39
    v_add_f32 v39, s34, v39
    v_add_f32 v39, s35, v39
    v_mov_b32 v72, s36
    v_add_f32 v72, s37, v72
    v_add_f32 v72, s38, v72
    v_add_f32 v72, s39, v72
    v_mov_b32 v73, s40
    v_add_f32 v73, s41, v73
    v_add_f32 v73, s42, v73
    v_add_f32 v73, s43, v73
    v_mov_b32 v74, s44
    v_add_f32 v74, s45, v74
    v_add_f32 v74, s46, v74
    v_add_f32 v74, s47, v74
    v_mov_b32 v75, s48
    v_add_f32 v75, s49, v75
    v_add_f32 v75, s50, v75
    v_add_f32 v75, s51, v75
    v_mul_f32 v36, 0x3b000000, v36
    v_mul_f32 v72, 0x3b000000, v72
    v_mul_f32 v37, 0x3b000000, v37
    v_mul_f32 v73, 0x3b000000, v73
    v_mul_f32 v38, 0x3b000000, v38
    v_mul_f32 v74, 0x3b000000, v74
    v_mul_f32 v39, 0x3b000000, v39
    v_mul_f32 v75, 0x3b000000, v75
    v_fma_f32 v72, -v36, v36, v72
    v_fma_f32 v73, -v37, v37, v73
    v_fma_f32 v74, -v38, v38, v74
    v_fma_f32 v75, -v39, v39, v75
    v_max_f32 v72, 0, v72
    v_max_f32 v73, 0, v73
    v_max_f32 v74, 0, v74
    v_max_f32 v75, 0, v75
    v_cvt_pk_bf16_f32 v36, v36, v72
    v_cvt_pk_bf16_f32 v37, v37, v73
    v_cvt_pk_bf16_f32 v38, v38, v74
    v_cvt_pk_bf16_f32 v39, v39, v75
    v_and_b32 v72, s17, v36
    v_lshlrev_b32 v36, 16, v36
    v_and_b32 v73, s17, v37
    v_lshlrev_b32 v37, 16, v37
    v_and_b32 v74, s17, v38
    v_lshlrev_b32 v38, 16, v38
    v_and_b32 v75, s17, v39
    v_lshlrev_b32 v39, 16, v39
    v_add_f32 v72, 0x3727c5ac, v72
    v_add_f32 v73, 0x3727c5ac, v73
    v_add_f32 v74, 0x3727c5ac, v74
    v_add_f32 v75, 0x3727c5ac, v75
    v_cvt_pk_bf16_f32 v72, v72, v72
    v_cvt_pk_bf16_f32 v73, v73, v73
    v_cvt_pk_bf16_f32 v74, v74, v74
    v_cvt_pk_bf16_f32 v75, v75, v75
    v_lshlrev_b32 v72, 16, v72
    v_lshlrev_b32 v73, 16, v73
    v_lshlrev_b32 v74, 16, v74
    v_lshlrev_b32 v75, 16, v75
    v_sqrt_f32 v72, v72
    v_sqrt_f32 v73, v73
    v_sqrt_f32 v74, v74
    v_sqrt_f32 v75, v75
    v_cvt_pk_bf16_f32 v72, v72, v72
    v_cvt_pk_bf16_f32 v73, v73, v73
    v_cvt_pk_bf16_f32 v74, v74, v74
    v_cvt_pk_bf16_f32 v75, v75, v75
    v_lshlrev_b32 v72, 16, v72
    v_lshlrev_b32 v73, 16, v73
    v_lshlrev_b32 v74, 16, v74
    v_lshlrev_b32 v75, 16, v75
    v_rcp_f32 v72, v72
    v_rcp_f32 v73, v73
    v_rcp_f32 v74, v74
    v_rcp_f32 v75, v75
    v_pk_add_f32 v[40:41], v[40:41], v[36:37] op_sel:[0,0] op_sel_hi:[1,0] neg_lo:[0,1] neg_hi:[0,1]
    v_pk_add_f32 v[42:43], v[42:43], v[36:37] op_sel:[0,0] op_sel_hi:[1,0] neg_lo:[0,1] neg_hi:[0,1]
    v_pk_add_f32 v[44:45], v[44:45], v[36:37] op_sel:[0,0] op_sel_hi:[1,0] neg_lo:[0,1] neg_hi:[0,1]
    v_pk_add_f32 v[46:47], v[46:47], v[36:37] op_sel:[0,0] op_sel_hi:[1,0] neg_lo:[0,1] neg_hi:[0,1]
    v_pk_add_f32 v[48:49], v[48:49], v[36:37] op_sel:[0,1] op_sel_hi:[1,1] neg_lo:[0,1] neg_hi:[0,1]
    v_pk_add_f32 v[50:51], v[50:51], v[36:37] op_sel:[0,1] op_sel_hi:[1,1] neg_lo:[0,1] neg_hi:[0,1]
    v_pk_add_f32 v[52:53], v[52:53], v[36:37] op_sel:[0,1] op_sel_hi:[1,1] neg_lo:[0,1] neg_hi:[0,1]
    v_pk_add_f32 v[54:55], v[54:55], v[36:37] op_sel:[0,1] op_sel_hi:[1,1] neg_lo:[0,1] neg_hi:[0,1]
    v_pk_add_f32 v[56:57], v[56:57], v[38:39] op_sel:[0,0] op_sel_hi:[1,0] neg_lo:[0,1] neg_hi:[0,1]
    v_pk_add_f32 v[58:59], v[58:59], v[38:39] op_sel:[0,0] op_sel_hi:[1,0] neg_lo:[0,1] neg_hi:[0,1]
    v_pk_add_f32 v[60:61], v[60:61], v[38:39] op_sel:[0,0] op_sel_hi:[1,0] neg_lo:[0,1] neg_hi:[0,1]
    v_pk_add_f32 v[62:63], v[62:63], v[38:39] op_sel:[0,0] op_sel_hi:[1,0] neg_lo:[0,1] neg_hi:[0,1]
    v_pk_add_f32 v[64:65], v[64:65], v[38:39] op_sel:[0,1] op_sel_hi:[1,1] neg_lo:[0,1] neg_hi:[0,1]
    v_pk_add_f32 v[66:67], v[66:67], v[38:39] op_sel:[0,1] op_sel_hi:[1,1] neg_lo:[0,1] neg_hi:[0,1]
    v_pk_add_f32 v[68:69], v[68:69], v[38:39] op_sel:[0,1] op_sel_hi:[1,1] neg_lo:[0,1] neg_hi:[0,1]
    v_pk_add_f32 v[70:71], v[70:71], v[38:39] op_sel:[0,1] op_sel_hi:[1,1] neg_lo:[0,1] neg_hi:[0,1]
    v_cvt_pk_bf16_f32 v40, v40, v41
    v_cvt_pk_bf16_f32 v42, v42, v43
    v_cvt_pk_bf16_f32 v44, v44, v45
    v_cvt_pk_bf16_f32 v46, v46, v47
    v_cvt_pk_bf16_f32 v48, v48, v49
    v_cvt_pk_bf16_f32 v50, v50, v51
    v_cvt_pk_bf16_f32 v52, v52, v53
    v_cvt_pk_bf16_f32 v54, v54, v55
    v_cvt_pk_bf16_f32 v56, v56, v57
    v_cvt_pk_bf16_f32 v58, v58, v59
    v_cvt_pk_bf16_f32 v60, v60, v61
    v_cvt_pk_bf16_f32 v62, v62, v63
    v_cvt_pk_bf16_f32 v64, v64, v65
    v_cvt_pk_bf16_f32 v66, v66, v67
    v_cvt_pk_bf16_f32 v68, v68, v69
    v_cvt_pk_bf16_f32 v70, v70, v71
    v_and_b32 v41, s17, v40
    v_lshlrev_b32 v40, 16, v40
    v_and_b32 v43, s17, v42
    v_lshlrev_b32 v42, 16, v42
    v_and_b32 v45, s17, v44
    v_lshlrev_b32 v44, 16, v44
    v_and_b32 v47, s17, v46
    v_lshlrev_b32 v46, 16, v46
    v_and_b32 v49, s17, v48
    v_lshlrev_b32 v48, 16, v48
    v_and_b32 v51, s17, v50
    v_lshlrev_b32 v50, 16, v50
    v_and_b32 v53, s17, v52
    v_lshlrev_b32 v52, 16, v52
    v_and_b32 v55, s17, v54
    v_lshlrev_b32 v54, 16, v54
    v_and_b32 v57, s17, v56
    v_lshlrev_b32 v56, 16, v56
    v_and_b32 v59, s17, v58
    v_lshlrev_b32 v58, 16, v58
    v_and_b32 v61, s17, v60
    v_lshlrev_b32 v60, 16, v60
    v_and_b32 v63, s17, v62
    v_lshlrev_b32 v62, 16, v62
    v_and_b32 v65, s17, v64
    v_lshlrev_b32 v64, 16, v64
    v_and_b32 v67, s17, v66
    v_lshlrev_b32 v66, 16, v66
    v_and_b32 v69, s17, v68
    v_lshlrev_b32 v68, 16, v68
    v_and_b32 v71, s17, v70
    v_lshlrev_b32 v70, 16, v70
    v_pk_mul_f32 v[40:41], v[40:41], v[72:73] op_sel:[0,0] op_sel_hi:[1,0]
    v_pk_mul_f32 v[48:49], v[48:49], v[72:73] op_sel:[0,1] op_sel_hi:[1,1]
    v_pk_mul_f32 v[56:57], v[56:57], v[74:75] op_sel:[0,0] op_sel_hi:[1,0]
    v_pk_mul_f32 v[64:65], v[64:65], v[74:75] op_sel:[0,1] op_sel_hi:[1,1]
    v_cvt_pk_bf16_f32 v21, v40, v41
    v_mov_b32 v20, v4
    v_cvt_pk_bf16_f32 v23, v48, v49
    v_mov_b32 v22, v8
    v_cvt_pk_bf16_f32 v25, v56, v57
    v_mov_b32 v24, v12
    v_cvt_pk_bf16_f32 v27, v64, v65
    v_mov_b32 v26, v16
    ds_write_b128 v3, v[20:23] offset:0
    ds_write_b128 v3, v[24:27] offset:16
    v_pk_mul_f32 v[42:43], v[42:43], v[72:73] op_sel:[0,0] op_sel_hi:[1,0]
    v_pk_mul_f32 v[50:51], v[50:51], v[72:73] op_sel:[0,1] op_sel_hi:[1,1]
    v_pk_mul_f32 v[58:59], v[58:59], v[74:75] op_sel:[0,0] op_sel_hi:[1,0]
    v_pk_mul_f32 v[66:67], v[66:67], v[74:75] op_sel:[0,1] op_sel_hi:[1,1]
    v_cvt_pk_bf16_f32 v29, v42, v43
    v_mov_b32 v28, v5
    v_cvt_pk_bf16_f32 v31, v50, v51
    v_mov_b32 v30, v9
    v_cvt_pk_bf16_f32 v33, v58, v59
    v_mov_b32 v32, v13
    v_cvt_pk_bf16_f32 v35, v66, v67
    v_mov_b32 v34, v17
    ds_write_b128 v3, v[28:31] offset:144
    ds_write_b128 v3, v[32:35] offset:160
    v_pk_mul_f32 v[44:45], v[44:45], v[72:73] op_sel:[0,0] op_sel_hi:[1,0]
    v_pk_mul_f32 v[52:53], v[52:53], v[72:73] op_sel:[0,1] op_sel_hi:[1,1]
    v_pk_mul_f32 v[60:61], v[60:61], v[74:75] op_sel:[0,0] op_sel_hi:[1,0]
    v_pk_mul_f32 v[68:69], v[68:69], v[74:75] op_sel:[0,1] op_sel_hi:[1,1]
    v_cvt_pk_bf16_f32 v21, v44, v45
    v_mov_b32 v20, v6
    v_cvt_pk_bf16_f32 v23, v52, v53
    v_mov_b32 v22, v10
    v_cvt_pk_bf16_f32 v25, v60, v61
    v_mov_b32 v24, v14
    v_cvt_pk_bf16_f32 v27, v68, v69
    v_mov_b32 v26, v18
    ds_write_b128 v3, v[20:23] offset:288
    ds_write_b128 v3, v[24:27] offset:304
    v_pk_mul_f32 v[46:47], v[46:47], v[72:73] op_sel:[0,0] op_sel_hi:[1,0]
    v_pk_mul_f32 v[54:55], v[54:55], v[72:73] op_sel:[0,1] op_sel_hi:[1,1]
    v_pk_mul_f32 v[62:63], v[62:63], v[74:75] op_sel:[0,0] op_sel_hi:[1,0]
    v_pk_mul_f32 v[70:71], v[70:71], v[74:75] op_sel:[0,1] op_sel_hi:[1,1]
    v_cvt_pk_bf16_f32 v29, v46, v47
    v_mov_b32 v28, v7
    v_cvt_pk_bf16_f32 v31, v54, v55
    v_mov_b32 v30, v11
    v_cvt_pk_bf16_f32 v33, v62, v63
    v_mov_b32 v32, v15
    v_cvt_pk_bf16_f32 v35, v70, v71
    v_mov_b32 v34, v19
    ds_write_b128 v3, v[28:31] offset:432
    ds_write_b128 v3, v[32:35] offset:448
    s_waitcnt lgkmcnt(0)
    s_barrier
    ds_read_b128 v[40:43], v82 offset:0
    ds_read_b128 v[44:47], v82 offset:4608
    ds_read_b128 v[48:51], v82 offset:9216
    ds_read_b128 v[52:55], v82 offset:13824
    ds_read_b128 v[56:59], v82 offset:18432
    ds_read_b128 v[60:63], v82 offset:23040
    ds_read_b128 v[64:67], v82 offset:27648
    ds_read_b128 v[68:71], v82 offset:32256
    s_waitcnt lgkmcnt(7)
    buffer_store_dwordx4 v[40:43], v83, s[8:11], s16 offen sc0 sc1
    s_add_u32 s16, s16, 532480
    s_waitcnt lgkmcnt(6)
    buffer_store_dwordx4 v[44:47], v83, s[8:11], s16 offen sc0 sc1
    s_add_u32 s16, s16, 532480
    s_waitcnt lgkmcnt(5)
    buffer_store_dwordx4 v[48:51], v83, s[8:11], s16 offen sc0 sc1
    s_add_u32 s16, s16, 532480
    s_waitcnt lgkmcnt(4)
    buffer_store_dwordx4 v[52:55], v83, s[8:11], s16 offen sc0 sc1
    s_add_u32 s16, s16, 532480
    s_waitcnt lgkmcnt(3)
    buffer_store_dwordx4 v[56:59], v83, s[8:11], s16 offen sc0 sc1
    s_add_u32 s16, s16, 532480
    s_waitcnt lgkmcnt(2)
    buffer_store_dwordx4 v[60:63], v83, s[8:11], s16 offen sc0 sc1
    s_add_u32 s16, s16, 532480
    s_waitcnt lgkmcnt(1)
    buffer_store_dwordx4 v[64:67], v83, s[8:11], s16 offen sc0 sc1
    s_add_u32 s16, s16, 532480
    s_waitcnt lgkmcnt(0)
    buffer_store_dwordx4 v[68:71], v83, s[8:11], s16 offen sc0 sc1
    s_add_u32 s16, s16, 532480
    s_endpgm
K1_W2:
    s_endpgm
K1_MOD:
    s_load_dwordx2 s[4:5], s[0:1], 120
    s_load_dwordx2 s[8:9], s[0:1], 112
    s_load_dwordx2 s[12:13], s[0:1], 144
    s_waitcnt lgkmcnt(0)
    s_and_b32 s5, s5, 0xffff
    s_mov_b32 s6, 0x300000
    s_mov_b32 s7, 0x00020000
    s_and_b32 s9, s9, 0xffff
    s_mov_b32 s10, 0x400
    s_mov_b32 s11, 0x00020000
    s_add_u32 s12, s12, 0x210000
    s_addc_u32 s13, s13, 0
    s_and_b32 s13, s13, 0xffff
    s_mov_b32 s14, 0xc000
    s_mov_b32 s15, 0x00020000
    s_sub_u32 s3, s2, 128
    s_and_b32 s16, s3, 3
    s_lshr_b32 s17, s3, 2
    v_and_b32 v3, 7, v0
    v_lshrrev_b32 v4, 3, v0
    s_lshl_b32 s18, s16, 7
    v_add_u32 v5, s18, v4
    v_lshlrev_b32 v6, 1, v5
    v_mul_u32_u24 v5, 6144, v5
    v_lshl_add_u32 v5, v3, 4, v5
    s_lshl_b32 s19, s17, 7
    s_mov_b32 s21, 0xffff0000

    buffer_load_ushort v8, v6, s[8:11], 0 offen offset:0
    buffer_load_ushort v9, v6, s[8:11], 0 offen offset:64
    buffer_load_ushort v10, v6, s[8:11], 0 offen offset:128
    buffer_load_ushort v11, v6, s[8:11], 0 offen offset:192
    buffer_load_dwordx4 v[12:15], v5, s[4:7], s19 offen
    s_add_u32 s19, s19, 196608
    buffer_load_dwordx4 v[16:19], v5, s[4:7], s19 offen
    s_add_u32 s19, s19, 196608
    buffer_load_dwordx4 v[20:23], v5, s[4:7], s19 offen
    s_add_u32 s19, s19, 196608
    buffer_load_dwordx4 v[24:27], v5, s[4:7], s19 offen
    s_waitcnt vmcnt(4)
    v_lshlrev_b32 v8, 16, v8
    v_lshlrev_b32 v9, 16, v9
    v_lshlrev_b32 v10, 16, v10
    v_lshlrev_b32 v11, 16, v11
    v_mul_f32 v28, 0xbfb8aa3b, v8
    v_mul_f32 v29, 0xbfb8aa3b, v9
    v_mul_f32 v30, 0xbfb8aa3b, v10
    v_mul_f32 v31, 0xbfb8aa3b, v11
    v_exp_f32 v28, v28
    v_exp_f32 v29, v29
    v_exp_f32 v30, v30
    v_exp_f32 v31, v31
    v_add_f32 v28, 1.0, v28
    v_add_f32 v29, 1.0, v29
    v_add_f32 v30, 1.0, v30
    v_add_f32 v31, 1.0, v31
    v_rcp_f32 v28, v28
    v_rcp_f32 v29, v29
    v_rcp_f32 v30, v30
    v_rcp_f32 v31, v31
    v_mul_f32 v8, v8, v28
    v_mul_f32 v9, v9, v29
    v_mul_f32 v10, v10, v30
    v_mul_f32 v11, v11, v31
    v_cvt_pk_bf16_f32 v8, v8, v8
    v_cvt_pk_bf16_f32 v9, v9, v9
    v_cvt_pk_bf16_f32 v10, v10, v10
    v_cvt_pk_bf16_f32 v11, v11, v11
    v_lshlrev_b32 v8, 16, v8
    v_lshlrev_b32 v9, 16, v9
    v_lshlrev_b32 v10, 16, v10
    v_lshlrev_b32 v11, 16, v11
    v_mov_b32 v32, 0
    v_mov_b32 v33, 0
    v_mov_b32 v34, 0
    v_mov_b32 v35, 0
    v_mov_b32 v36, 0
    v_mov_b32 v37, 0
    v_mov_b32 v38, 0
    v_mov_b32 v39, 0
    s_waitcnt vmcnt(3)
    v_lshlrev_b32 v28, 16, v12
    v_and_b32 v29, s21, v12
    v_fmac_f32 v32, v8, v28
    v_fmac_f32 v33, v8, v29
    v_lshlrev_b32 v28, 16, v13
    v_and_b32 v29, s21, v13
    v_fmac_f32 v34, v8, v28
    v_fmac_f32 v35, v8, v29
    v_lshlrev_b32 v28, 16, v14
    v_and_b32 v29, s21, v14
    v_fmac_f32 v36, v8, v28
    v_fmac_f32 v37, v8, v29
    v_lshlrev_b32 v28, 16, v15
    v_and_b32 v29, s21, v15
    v_fmac_f32 v38, v8, v28
    v_fmac_f32 v39, v8, v29
    s_waitcnt vmcnt(2)
    v_lshlrev_b32 v28, 16, v16
    v_and_b32 v29, s21, v16
    v_fmac_f32 v32, v9, v28
    v_fmac_f32 v33, v9, v29
    v_lshlrev_b32 v28, 16, v17
    v_and_b32 v29, s21, v17
    v_fmac_f32 v34, v9, v28
    v_fmac_f32 v35, v9, v29
    v_lshlrev_b32 v28, 16, v18
    v_and_b32 v29, s21, v18
    v_fmac_f32 v36, v9, v28
    v_fmac_f32 v37, v9, v29
    v_lshlrev_b32 v28, 16, v19
    v_and_b32 v29, s21, v19
    v_fmac_f32 v38, v9, v28
    v_fmac_f32 v39, v9, v29
    s_waitcnt vmcnt(1)
    v_lshlrev_b32 v28, 16, v20
    v_and_b32 v29, s21, v20
    v_fmac_f32 v32, v10, v28
    v_fmac_f32 v33, v10, v29
    v_lshlrev_b32 v28, 16, v21
    v_and_b32 v29, s21, v21
    v_fmac_f32 v34, v10, v28
    v_fmac_f32 v35, v10, v29
    v_lshlrev_b32 v28, 16, v22
    v_and_b32 v29, s21, v22
    v_fmac_f32 v36, v10, v28
    v_fmac_f32 v37, v10, v29
    v_lshlrev_b32 v28, 16, v23
    v_and_b32 v29, s21, v23
    v_fmac_f32 v38, v10, v28
    v_fmac_f32 v39, v10, v29
    s_waitcnt vmcnt(0)
    v_lshlrev_b32 v28, 16, v24
    v_and_b32 v29, s21, v24
    v_fmac_f32 v32, v11, v28
    v_fmac_f32 v33, v11, v29
    v_lshlrev_b32 v28, 16, v25
    v_and_b32 v29, s21, v25
    v_fmac_f32 v34, v11, v28
    v_fmac_f32 v35, v11, v29
    v_lshlrev_b32 v28, 16, v26
    v_and_b32 v29, s21, v26
    v_fmac_f32 v36, v11, v28
    v_fmac_f32 v37, v11, v29
    v_lshlrev_b32 v28, 16, v27
    v_and_b32 v29, s21, v27
    v_fmac_f32 v38, v11, v28
    v_fmac_f32 v39, v11, v29
    v_mul_u32_u24 v5, 272, v4
    v_lshl_add_u32 v5, v3, 5, v5
    ds_write_b128 v5, v[32:35]
    ds_write_b128 v5, v[36:39] offset:16
    v_mul_u32_u24 v6, 2176, v2
    v_lshl_add_u32 v6, v1, 2, v6
    s_waitcnt lgkmcnt(0)
    s_barrier

    ds_read_b32 v8, v6 offset:0
    ds_read_b32 v9, v6 offset:272
    ds_read_b32 v10, v6 offset:544
    ds_read_b32 v11, v6 offset:816
    ds_read_b32 v12, v6 offset:1088
    ds_read_b32 v13, v6 offset:1360
    ds_read_b32 v14, v6 offset:1632
    ds_read_b32 v15, v6 offset:1904
    s_waitcnt lgkmcnt(0)
    v_add_f32 v8, v8, v9
    v_add_f32 v8, v8, v10
    v_add_f32 v8, v8, v11
    v_add_f32 v8, v8, v12
    v_add_f32 v8, v8, v13
    v_add_f32 v8, v8, v14
    v_add_f32 v8, v8, v15
    v_lshlrev_b32 v6, 2, v0
    ds_write_b32 v6, v8 offset:8704
    v_lshlrev_b32 v6, 2, v1
    s_waitcnt lgkmcnt(0)
    s_barrier

    ds_read_b32 v8, v6 offset:8704
    ds_read_b32 v9, v6 offset:8960
    ds_read_b32 v10, v6 offset:9216
    ds_read_b32 v11, v6 offset:9472
    s_and_b32 s18, s17, 7
    s_mul_i32 s18, s18, 6144
    s_lshr_b32 s19, s17, 3
    s_lshl_b32 s19, s19, 4
    s_add_u32 s18, s18, s19
    s_lshl_b32 s19, s16, 2
    s_add_u32 s18, s18, s19
    v_mul_u32_u24 v7, 96, v1
    s_waitcnt lgkmcnt(0)
    v_add_f32 v8, v8, v9
    v_add_f32 v10, v10, v11
    v_add_f32 v8, v8, v10
    v_cmp_gt_u32 vcc, 64, v0
    s_and_saveexec_b64 s[22:23], vcc
    s_cbranch_execz K1_END
    buffer_store_dword v8, v7, s[12:15], s18 offen sc0 sc1
    s_endpgm

K1_KG0:
    s_mov_b32 s2, s3
K1_KG:
    s_load_dwordx16 s[4:19], s[0:1], 0
    s_load_dwordx2 s[32:33], s[0:1], 144
    s_lshl_b32 s36, s3, 8
    s_lshl_b32 s37, s3, 1
    v_and_b32 v3, 127, v0
    v_lshl_add_u32 v4, v3, 1, s36
    v_mov_b32 v5, s37
    s_waitcnt lgkmcnt(0)

    global_load_ushort v8, v4, s[6:7]
    global_load_ushort v9, v4, s[8:9]
    global_load_ushort v10, v4, s[10:11]
    global_load_ushort v11, v4, s[12:13]
    global_load_ushort v12, v4, s[14:15]
    global_load_ushort v13, v4, s[16:17]
    global_load_ushort v14, v5, s[18:19]
    s_waitcnt lgkmcnt(0)
    s_add_u32 s32, s32, 0x300000
    s_addc_u32 s33, s33, 0
    s_and_b32 s33, s33, 0xffff
    s_mov_b32 s34, 0x210000
    s_mov_b32 s35, 0x00020000
    v_lshlrev_b32 v6, 3, v0
    v_sub_u32 v6, 2047, v6
    v_subrev_u32 v80, 0, v6
    v_subrev_u32 v81, 1, v6
    v_subrev_u32 v82, 2, v6
    v_subrev_u32 v83, 3, v6
    v_subrev_u32 v84, 4, v6
    v_subrev_u32 v85, 5, v6
    v_subrev_u32 v86, 6, v6
    v_subrev_u32 v87, 7, v6
    v_cvt_f32_u32 v88, v80
    v_cvt_f32_u32 v89, v81
    v_cvt_f32_u32 v90, v82
    v_cvt_f32_u32 v91, v83
    v_cvt_f32_u32 v92, v84
    v_cvt_f32_u32 v93, v85
    v_cvt_f32_u32 v94, v86
    v_cvt_f32_u32 v95, v87
    v_cvt_pk_bf16_f32 v88, v88, v88
    v_cvt_pk_bf16_f32 v89, v89, v89
    v_cvt_pk_bf16_f32 v90, v90, v90
    v_cvt_pk_bf16_f32 v91, v91, v91
    v_cvt_pk_bf16_f32 v92, v92, v92
    v_cvt_pk_bf16_f32 v93, v93, v93
    v_cvt_pk_bf16_f32 v94, v94, v94
    v_cvt_pk_bf16_f32 v95, v95, v95
    v_and_b32 v88, 0xffff, v88
    v_and_b32 v89, 0xffff, v89
    v_and_b32 v90, 0xffff, v90
    v_and_b32 v91, 0xffff, v91
    v_and_b32 v92, 0xffff, v92
    v_and_b32 v93, 0xffff, v93
    v_and_b32 v94, 0xffff, v94
    v_and_b32 v95, 0xffff, v95
    v_subrev_u32 v88, 17024, v88
    v_subrev_u32 v89, 17024, v89
    v_subrev_u32 v90, 17024, v90
    v_subrev_u32 v91, 17024, v91
    v_subrev_u32 v92, 17024, v92
    v_subrev_u32 v93, 17024, v93
    v_subrev_u32 v94, 17024, v94
    v_subrev_u32 v95, 17024, v95
    v_cmp_lt_u32 vcc, 127, v6
    s_nop 1
    v_cndmask_b32 v80, v80, v88, vcc
    v_cndmask_b32 v81, v81, v89, vcc
    v_cndmask_b32 v82, v82, v90, vcc
    v_cndmask_b32 v83, v83, v91, vcc
    v_cndmask_b32 v84, v84, v92, vcc
    v_cndmask_b32 v85, v85, v93, vcc
    v_cndmask_b32 v86, v86, v94, vcc
    v_cndmask_b32 v87, v87, v95, vcc
    v_lshlrev_b32 v80, 1, v80
    v_lshlrev_b32 v81, 1, v81
    v_lshlrev_b32 v82, 1, v82
    v_lshlrev_b32 v83, 1, v83
    v_lshlrev_b32 v84, 1, v84
    v_lshlrev_b32 v85, 1, v85
    v_lshlrev_b32 v86, 1, v86
    v_lshlrev_b32 v87, 1, v87
    v_and_b32 v6, 15, v1
    v_cvt_f32_u32 v6, v6
    v_lshrrev_b32 v7, 4, v1
    v_lshlrev_b32 v7, 6, v7
    v_lshl_add_u32 v7, v2, 9, v7
    s_waitcnt vmcnt(0)

    v_lshlrev_b32 v8, 16, v8
    v_lshlrev_b32 v9, 16, v9
    v_lshlrev_b32 v10, 16, v10
    v_lshlrev_b32 v11, 16, v11
    v_lshlrev_b32 v12, 16, v12
    v_lshlrev_b32 v13, 16, v13
    v_lshlrev_b32 v14, 16, v14
    v_mul_f32 v14, 0x3fb8aa3b, v14
    v_exp_f32 v14, v14
    s_nop 0
    v_cvt_pk_bf16_f32 v14, v14, v14
    v_lshlrev_b32 v14, 16, v14
    v_mul_f32 v16, v14, v8
    v_mul_f32 v17, v14, v9
    v_mul_f32 v10, v14, v10
    v_mul_f32 v11, v14, v11
    v_mul_f32 v16, 0x3fb8aa3b, v16
    v_mul_f32 v17, 0.15915494, v17
    v_mul_f32 v18, v12, v10
    v_mul_f32 v19, v12, v11
    v_fma_f32 v18, -v13, v11, v18
    v_fma_f32 v19, v13, v10, v19
    v_lshlrev_b32 v4, 4, v3
    ds_write_b128 v4, v[16:19]
    v_mov_b32 v96, v16
    v_mov_b32 v97, v17
    v_mov_b32 v98, v18
    v_mov_b32 v99, v19
    s_waitcnt lgkmcnt(0)
    s_barrier

    ds_read_b128 v[8:11], v7 offset:0
    ds_read_b128 v[12:15], v7 offset:16
    ds_read_b128 v[16:19], v7 offset:32
    ds_read_b128 v[20:23], v7 offset:48
    ds_read_b128 v[24:27], v7 offset:256
    ds_read_b128 v[28:31], v7 offset:272
    ds_read_b128 v[32:35], v7 offset:288
    ds_read_b128 v[36:39], v7 offset:304
    v_mul_f32 v100, 0x45000000, v96
    v_mul_f32 v101, 0x45000000, v97
    v_exp_f32 v100, v100
    v_fract_f32 v101, v101
    v_cos_f32 v102, v101
    v_sin_f32 v101, v101
    s_nop 0
    v_mul_f32 v102, v98, v102
    v_fma_f32 v102, -v99, v101, v102
    v_mul_f32 v102, v100, v102

    s_nop 1
    v_add_f32_dpp v102, v102, v102 row_ror:8 row_mask:0xf bank_mask:0xf
    s_nop 1
    v_add_f32_dpp v102, v102, v102 row_ror:4 row_mask:0xf bank_mask:0xf
    s_nop 1
    v_add_f32_dpp v102, v102, v102 row_ror:2 row_mask:0xf bank_mask:0xf
    s_nop 1
    v_add_f32_dpp v102, v102, v102 row_ror:1 row_mask:0xf bank_mask:0xf
    s_nop 1
    v_readlane_b32 s40, v102, 0
    v_readlane_b32 s41, v102, 16
    v_readlane_b32 s42, v102, 32
    v_readlane_b32 s43, v102, 48
    s_nop 1
    v_mov_b32 v102, s40
    v_add_f32 v102, s41, v102
    v_add_f32 v102, s42, v102
    v_add_f32 v102, s43, v102
    v_lshlrev_b32 v4, 2, v2
    ds_write_b32 v4, v102 offset:19968
    s_waitcnt lgkmcnt(1)
    v_pk_mul_f32 v[72:73], v[8:9], v[6:7] op_sel_hi:[1,0]
    v_pk_mul_f32 v[76:77], v[12:13], v[6:7] op_sel_hi:[1,0]
    v_pk_mul_f32 v[88:89], v[16:17], v[6:7] op_sel_hi:[1,0]
    v_pk_mul_f32 v[92:93], v[20:21], v[6:7] op_sel_hi:[1,0]
    v_exp_f32 v72, v72
    v_fract_f32 v73, v73
    v_exp_f32 v76, v76
    v_fract_f32 v77, v77
    v_exp_f32 v88, v88
    v_fract_f32 v89, v89
    v_exp_f32 v92, v92
    v_fract_f32 v93, v93
    v_cos_f32 v74, v73
    v_sin_f32 v75, v73
    v_cos_f32 v78, v77
    v_sin_f32 v79, v77
    v_cos_f32 v90, v89
    v_sin_f32 v91, v89
    v_cos_f32 v94, v93
    v_sin_f32 v95, v93
    v_pk_mul_f32 v[72:73], v[74:75], v[72:73] op_sel_hi:[1,0]
    v_pk_mul_f32 v[76:77], v[78:79], v[76:77] op_sel_hi:[1,0]
    v_pk_mul_f32 v[88:89], v[90:91], v[88:89] op_sel_hi:[1,0]
    v_pk_mul_f32 v[92:93], v[94:95], v[92:93] op_sel_hi:[1,0]
    v_cvt_pk_bf16_f32 v40, v72, v73
    v_cvt_pk_bf16_f32 v41, v76, v77
    v_cvt_pk_bf16_f32 v42, v88, v89
    v_cvt_pk_bf16_f32 v43, v92, v93
    v_pk_mul_f32 v[74:75], v[72:73], v[72:73] op_sel_hi:[0,1]
    v_pk_mul_f32 v[78:79], v[76:77], v[76:77] op_sel_hi:[0,1]
    v_pk_mul_f32 v[90:91], v[88:89], v[88:89] op_sel_hi:[0,1]
    v_pk_mul_f32 v[94:95], v[92:93], v[92:93] op_sel_hi:[0,1]
    v_pk_fma_f32 v[72:73], v[72:73], v[72:73], v[74:75] op_sel:[1,1,0] op_sel_hi:[1,0,1] neg_lo:[0,1,0]
    v_pk_fma_f32 v[76:77], v[76:77], v[76:77], v[78:79] op_sel:[1,1,0] op_sel_hi:[1,0,1] neg_lo:[0,1,0]
    v_pk_fma_f32 v[88:89], v[88:89], v[88:89], v[90:91] op_sel:[1,1,0] op_sel_hi:[1,0,1] neg_lo:[0,1,0]
    v_pk_fma_f32 v[92:93], v[92:93], v[92:93], v[94:95] op_sel:[1,1,0] op_sel_hi:[1,0,1] neg_lo:[0,1,0]
    v_cvt_pk_bf16_f32 v44, v72, v73
    v_cvt_pk_bf16_f32 v45, v76, v77
    v_cvt_pk_bf16_f32 v46, v88, v89
    v_cvt_pk_bf16_f32 v47, v92, v93
    v_pk_mul_f32 v[74:75], v[72:73], v[72:73] op_sel_hi:[0,1]
    v_pk_mul_f32 v[78:79], v[76:77], v[76:77] op_sel_hi:[0,1]
    v_pk_mul_f32 v[90:91], v[88:89], v[88:89] op_sel_hi:[0,1]
    v_pk_mul_f32 v[94:95], v[92:93], v[92:93] op_sel_hi:[0,1]
    v_pk_fma_f32 v[72:73], v[72:73], v[72:73], v[74:75] op_sel:[1,1,0] op_sel_hi:[1,0,1] neg_lo:[0,1,0]
    v_pk_fma_f32 v[76:77], v[76:77], v[76:77], v[78:79] op_sel:[1,1,0] op_sel_hi:[1,0,1] neg_lo:[0,1,0]
    v_pk_fma_f32 v[88:89], v[88:89], v[88:89], v[90:91] op_sel:[1,1,0] op_sel_hi:[1,0,1] neg_lo:[0,1,0]
    v_pk_fma_f32 v[92:93], v[92:93], v[92:93], v[94:95] op_sel:[1,1,0] op_sel_hi:[1,0,1] neg_lo:[0,1,0]
    v_cvt_pk_bf16_f32 v48, v72, v73
    v_cvt_pk_bf16_f32 v49, v76, v77
    v_cvt_pk_bf16_f32 v50, v88, v89
    v_cvt_pk_bf16_f32 v51, v92, v93
    v_pk_mul_f32 v[74:75], v[72:73], v[72:73] op_sel_hi:[0,1]
    v_pk_mul_f32 v[78:79], v[76:77], v[76:77] op_sel_hi:[0,1]
    v_pk_mul_f32 v[90:91], v[88:89], v[88:89] op_sel_hi:[0,1]
    v_pk_mul_f32 v[94:95], v[92:93], v[92:93] op_sel_hi:[0,1]
    v_pk_fma_f32 v[72:73], v[72:73], v[72:73], v[74:75] op_sel:[1,1,0] op_sel_hi:[1,0,1] neg_lo:[0,1,0]
    v_pk_fma_f32 v[76:77], v[76:77], v[76:77], v[78:79] op_sel:[1,1,0] op_sel_hi:[1,0,1] neg_lo:[0,1,0]
    v_pk_fma_f32 v[88:89], v[88:89], v[88:89], v[90:91] op_sel:[1,1,0] op_sel_hi:[1,0,1] neg_lo:[0,1,0]
    v_pk_fma_f32 v[92:93], v[92:93], v[92:93], v[94:95] op_sel:[1,1,0] op_sel_hi:[1,0,1] neg_lo:[0,1,0]
    v_cvt_pk_bf16_f32 v52, v72, v73
    v_cvt_pk_bf16_f32 v53, v76, v77
    v_cvt_pk_bf16_f32 v54, v88, v89
    v_cvt_pk_bf16_f32 v55, v92, v93
    v_pk_mul_f32 v[74:75], v[72:73], v[72:73] op_sel_hi:[0,1]
    v_pk_mul_f32 v[78:79], v[76:77], v[76:77] op_sel_hi:[0,1]
    v_pk_mul_f32 v[90:91], v[88:89], v[88:89] op_sel_hi:[0,1]
    v_pk_mul_f32 v[94:95], v[92:93], v[92:93] op_sel_hi:[0,1]
    v_pk_fma_f32 v[72:73], v[72:73], v[72:73], v[74:75] op_sel:[1,1,0] op_sel_hi:[1,0,1] neg_lo:[0,1,0]
    v_pk_fma_f32 v[76:77], v[76:77], v[76:77], v[78:79] op_sel:[1,1,0] op_sel_hi:[1,0,1] neg_lo:[0,1,0]
    v_pk_fma_f32 v[88:89], v[88:89], v[88:89], v[90:91] op_sel:[1,1,0] op_sel_hi:[1,0,1] neg_lo:[0,1,0]
    v_pk_fma_f32 v[92:93], v[92:93], v[92:93], v[94:95] op_sel:[1,1,0] op_sel_hi:[1,0,1] neg_lo:[0,1,0]
    v_pk_mul_f32 v[74:75], v[10:11], v[72:73] op_sel_hi:[0,1]
    v_pk_mul_f32 v[78:79], v[14:15], v[76:77] op_sel_hi:[0,1]
    v_pk_mul_f32 v[90:91], v[18:19], v[88:89] op_sel_hi:[0,1]
    v_pk_mul_f32 v[94:95], v[22:23], v[92:93] op_sel_hi:[0,1]
    v_pk_fma_f32 v[74:75], v[10:11], v[72:73], v[74:75] op_sel:[1,1,0] op_sel_hi:[1,0,1] neg_lo:[0,1,0]
    v_pk_fma_f32 v[78:79], v[14:15], v[76:77], v[78:79] op_sel:[1,1,0] op_sel_hi:[1,0,1] neg_lo:[0,1,0]
    v_pk_fma_f32 v[90:91], v[18:19], v[88:89], v[90:91] op_sel:[1,1,0] op_sel_hi:[1,0,1] neg_lo:[0,1,0]
    v_pk_fma_f32 v[94:95], v[22:23], v[92:93], v[94:95] op_sel:[1,1,0] op_sel_hi:[1,0,1] neg_lo:[0,1,0]
    v_cvt_pk_bf16_f32 v56, v74, -v75
    v_cvt_pk_bf16_f32 v57, v78, -v79
    v_cvt_pk_bf16_f32 v58, v90, -v91
    v_cvt_pk_bf16_f32 v59, v94, -v95
    v_pk_mul_f32 v[74:75], v[72:73], v[72:73] op_sel_hi:[0,1]
    v_pk_mul_f32 v[78:79], v[76:77], v[76:77] op_sel_hi:[0,1]
    v_pk_mul_f32 v[90:91], v[88:89], v[88:89] op_sel_hi:[0,1]
    v_pk_mul_f32 v[94:95], v[92:93], v[92:93] op_sel_hi:[0,1]
    v_pk_fma_f32 v[72:73], v[72:73], v[72:73], v[74:75] op_sel:[1,1,0] op_sel_hi:[1,0,1] neg_lo:[0,1,0]
    v_pk_fma_f32 v[76:77], v[76:77], v[76:77], v[78:79] op_sel:[1,1,0] op_sel_hi:[1,0,1] neg_lo:[0,1,0]
    v_pk_fma_f32 v[88:89], v[88:89], v[88:89], v[90:91] op_sel:[1,1,0] op_sel_hi:[1,0,1] neg_lo:[0,1,0]
    v_pk_fma_f32 v[92:93], v[92:93], v[92:93], v[94:95] op_sel:[1,1,0] op_sel_hi:[1,0,1] neg_lo:[0,1,0]
    v_pk_mul_f32 v[74:75], v[10:11], v[72:73] op_sel_hi:[0,1]
    v_pk_mul_f32 v[78:79], v[14:15], v[76:77] op_sel_hi:[0,1]
    v_pk_mul_f32 v[90:91], v[18:19], v[88:89] op_sel_hi:[0,1]
    v_pk_mul_f32 v[94:95], v[22:23], v[92:93] op_sel_hi:[0,1]
    v_pk_fma_f32 v[74:75], v[10:11], v[72:73], v[74:75] op_sel:[1,1,0] op_sel_hi:[1,0,1] neg_lo:[0,1,0]
    v_pk_fma_f32 v[78:79], v[14:15], v[76:77], v[78:79] op_sel:[1,1,0] op_sel_hi:[1,0,1] neg_lo:[0,1,0]
    v_pk_fma_f32 v[90:91], v[18:19], v[88:89], v[90:91] op_sel:[1,1,0] op_sel_hi:[1,0,1] neg_lo:[0,1,0]
    v_pk_fma_f32 v[94:95], v[22:23], v[92:93], v[94:95] op_sel:[1,1,0] op_sel_hi:[1,0,1] neg_lo:[0,1,0]
    v_cvt_pk_bf16_f32 v60, v74, -v75
    v_cvt_pk_bf16_f32 v61, v78, -v79
    v_cvt_pk_bf16_f32 v62, v90, -v91
    v_cvt_pk_bf16_f32 v63, v94, -v95
    v_pk_mul_f32 v[74:75], v[72:73], v[72:73] op_sel_hi:[0,1]
    v_pk_mul_f32 v[78:79], v[76:77], v[76:77] op_sel_hi:[0,1]
    v_pk_mul_f32 v[90:91], v[88:89], v[88:89] op_sel_hi:[0,1]
    v_pk_mul_f32 v[94:95], v[92:93], v[92:93] op_sel_hi:[0,1]
    v_pk_fma_f32 v[72:73], v[72:73], v[72:73], v[74:75] op_sel:[1,1,0] op_sel_hi:[1,0,1] neg_lo:[0,1,0]
    v_pk_fma_f32 v[76:77], v[76:77], v[76:77], v[78:79] op_sel:[1,1,0] op_sel_hi:[1,0,1] neg_lo:[0,1,0]
    v_pk_fma_f32 v[88:89], v[88:89], v[88:89], v[90:91] op_sel:[1,1,0] op_sel_hi:[1,0,1] neg_lo:[0,1,0]
    v_pk_fma_f32 v[92:93], v[92:93], v[92:93], v[94:95] op_sel:[1,1,0] op_sel_hi:[1,0,1] neg_lo:[0,1,0]
    v_pk_mul_f32 v[74:75], v[10:11], v[72:73] op_sel_hi:[0,1]
    v_pk_mul_f32 v[78:79], v[14:15], v[76:77] op_sel_hi:[0,1]
    v_pk_mul_f32 v[90:91], v[18:19], v[88:89] op_sel_hi:[0,1]
    v_pk_mul_f32 v[94:95], v[22:23], v[92:93] op_sel_hi:[0,1]
    v_pk_fma_f32 v[74:75], v[10:11], v[72:73], v[74:75] op_sel:[1,1,0] op_sel_hi:[1,0,1] neg_lo:[0,1,0]
    v_pk_fma_f32 v[78:79], v[14:15], v[76:77], v[78:79] op_sel:[1,1,0] op_sel_hi:[1,0,1] neg_lo:[0,1,0]
    v_pk_fma_f32 v[90:91], v[18:19], v[88:89], v[90:91] op_sel:[1,1,0] op_sel_hi:[1,0,1] neg_lo:[0,1,0]
    v_pk_fma_f32 v[94:95], v[22:23], v[92:93], v[94:95] op_sel:[1,1,0] op_sel_hi:[1,0,1] neg_lo:[0,1,0]
    v_cvt_pk_bf16_f32 v64, v74, -v75
    v_cvt_pk_bf16_f32 v65, v78, -v79
    v_cvt_pk_bf16_f32 v66, v90, -v91
    v_cvt_pk_bf16_f32 v67, v94, -v95
    v_pk_mul_f32 v[74:75], v[72:73], v[72:73] op_sel_hi:[0,1]
    v_pk_mul_f32 v[78:79], v[76:77], v[76:77] op_sel_hi:[0,1]
    v_pk_mul_f32 v[90:91], v[88:89], v[88:89] op_sel_hi:[0,1]
    v_pk_mul_f32 v[94:95], v[92:93], v[92:93] op_sel_hi:[0,1]
    v_pk_fma_f32 v[72:73], v[72:73], v[72:73], v[74:75] op_sel:[1,1,0] op_sel_hi:[1,0,1] neg_lo:[0,1,0]
    v_pk_fma_f32 v[76:77], v[76:77], v[76:77], v[78:79] op_sel:[1,1,0] op_sel_hi:[1,0,1] neg_lo:[0,1,0]
    v_pk_fma_f32 v[88:89], v[88:89], v[88:89], v[90:91] op_sel:[1,1,0] op_sel_hi:[1,0,1] neg_lo:[0,1,0]
    v_pk_fma_f32 v[92:93], v[92:93], v[92:93], v[94:95] op_sel:[1,1,0] op_sel_hi:[1,0,1] neg_lo:[0,1,0]
    v_pk_mul_f32 v[74:75], v[10:11], v[72:73] op_sel_hi:[0,1]
    v_pk_mul_f32 v[78:79], v[14:15], v[76:77] op_sel_hi:[0,1]
    v_pk_mul_f32 v[90:91], v[18:19], v[88:89] op_sel_hi:[0,1]
    v_pk_mul_f32 v[94:95], v[22:23], v[92:93] op_sel_hi:[0,1]
    v_pk_fma_f32 v[74:75], v[10:11], v[72:73], v[74:75] op_sel:[1,1,0] op_sel_hi:[1,0,1] neg_lo:[0,1,0]
    v_pk_fma_f32 v[78:79], v[14:15], v[76:77], v[78:79] op_sel:[1,1,0] op_sel_hi:[1,0,1] neg_lo:[0,1,0]
    v_pk_fma_f32 v[90:91], v[18:19], v[88:89], v[90:91] op_sel:[1,1,0] op_sel_hi:[1,0,1] neg_lo:[0,1,0]
    v_pk_fma_f32 v[94:95], v[22:23], v[92:93], v[94:95] op_sel:[1,1,0] op_sel_hi:[1,0,1] neg_lo:[0,1,0]
    v_cvt_pk_bf16_f32 v68, v74, -v75
    v_cvt_pk_bf16_f32 v69, v78, -v79
    v_cvt_pk_bf16_f32 v70, v90, -v91
    v_cvt_pk_bf16_f32 v71, v94, -v95
    s_nop 1
    v_mfma_f32_16x16x32_bf16 v[96:99], v[40:43], v[56:59], 0
    v_mfma_f32_16x16x32_bf16 v[100:103], v[44:47], v[60:63], 0
    v_mfma_f32_16x16x32_bf16 v[104:107], v[48:51], v[64:67], 0
    v_mfma_f32_16x16x32_bf16 v[108:111], v[52:55], v[68:71], 0
    s_waitcnt lgkmcnt(0)
    v_pk_mul_f32 v[72:73], v[24:25], v[6:7] op_sel_hi:[1,0]
    v_pk_mul_f32 v[76:77], v[28:29], v[6:7] op_sel_hi:[1,0]
    v_pk_mul_f32 v[88:89], v[32:33], v[6:7] op_sel_hi:[1,0]
    v_pk_mul_f32 v[92:93], v[36:37], v[6:7] op_sel_hi:[1,0]
    v_exp_f32 v72, v72
    v_fract_f32 v73, v73
    v_exp_f32 v76, v76
    v_fract_f32 v77, v77
    v_exp_f32 v88, v88
    v_fract_f32 v89, v89
    v_exp_f32 v92, v92
    v_fract_f32 v93, v93
    v_cos_f32 v74, v73
    v_sin_f32 v75, v73
    v_cos_f32 v78, v77
    v_sin_f32 v79, v77
    v_cos_f32 v90, v89
    v_sin_f32 v91, v89
    v_cos_f32 v94, v93
    v_sin_f32 v95, v93
    v_pk_mul_f32 v[72:73], v[74:75], v[72:73] op_sel_hi:[1,0]
    v_pk_mul_f32 v[76:77], v[78:79], v[76:77] op_sel_hi:[1,0]
    v_pk_mul_f32 v[88:89], v[90:91], v[88:89] op_sel_hi:[1,0]
    v_pk_mul_f32 v[92:93], v[94:95], v[92:93] op_sel_hi:[1,0]
    v_cvt_pk_bf16_f32 v40, v72, v73
    v_cvt_pk_bf16_f32 v41, v76, v77
    v_cvt_pk_bf16_f32 v42, v88, v89
    v_cvt_pk_bf16_f32 v43, v92, v93
    v_pk_mul_f32 v[74:75], v[72:73], v[72:73] op_sel_hi:[0,1]
    v_pk_mul_f32 v[78:79], v[76:77], v[76:77] op_sel_hi:[0,1]
    v_pk_mul_f32 v[90:91], v[88:89], v[88:89] op_sel_hi:[0,1]
    v_pk_mul_f32 v[94:95], v[92:93], v[92:93] op_sel_hi:[0,1]
    v_pk_fma_f32 v[72:73], v[72:73], v[72:73], v[74:75] op_sel:[1,1,0] op_sel_hi:[1,0,1] neg_lo:[0,1,0]
    v_pk_fma_f32 v[76:77], v[76:77], v[76:77], v[78:79] op_sel:[1,1,0] op_sel_hi:[1,0,1] neg_lo:[0,1,0]
    v_pk_fma_f32 v[88:89], v[88:89], v[88:89], v[90:91] op_sel:[1,1,0] op_sel_hi:[1,0,1] neg_lo:[0,1,0]
    v_pk_fma_f32 v[92:93], v[92:93], v[92:93], v[94:95] op_sel:[1,1,0] op_sel_hi:[1,0,1] neg_lo:[0,1,0]
    v_cvt_pk_bf16_f32 v44, v72, v73
    v_cvt_pk_bf16_f32 v45, v76, v77
    v_cvt_pk_bf16_f32 v46, v88, v89
    v_cvt_pk_bf16_f32 v47, v92, v93
    v_pk_mul_f32 v[74:75], v[72:73], v[72:73] op_sel_hi:[0,1]
    v_pk_mul_f32 v[78:79], v[76:77], v[76:77] op_sel_hi:[0,1]
    v_pk_mul_f32 v[90:91], v[88:89], v[88:89] op_sel_hi:[0,1]
    v_pk_mul_f32 v[94:95], v[92:93], v[92:93] op_sel_hi:[0,1]
    v_pk_fma_f32 v[72:73], v[72:73], v[72:73], v[74:75] op_sel:[1,1,0] op_sel_hi:[1,0,1] neg_lo:[0,1,0]
    v_pk_fma_f32 v[76:77], v[76:77], v[76:77], v[78:79] op_sel:[1,1,0] op_sel_hi:[1,0,1] neg_lo:[0,1,0]
    v_pk_fma_f32 v[88:89], v[88:89], v[88:89], v[90:91] op_sel:[1,1,0] op_sel_hi:[1,0,1] neg_lo:[0,1,0]
    v_pk_fma_f32 v[92:93], v[92:93], v[92:93], v[94:95] op_sel:[1,1,0] op_sel_hi:[1,0,1] neg_lo:[0,1,0]
    v_cvt_pk_bf16_f32 v48, v72, v73
    v_cvt_pk_bf16_f32 v49, v76, v77
    v_cvt_pk_bf16_f32 v50, v88, v89
    v_cvt_pk_bf16_f32 v51, v92, v93
    v_pk_mul_f32 v[74:75], v[72:73], v[72:73] op_sel_hi:[0,1]
    v_pk_mul_f32 v[78:79], v[76:77], v[76:77] op_sel_hi:[0,1]
    v_pk_mul_f32 v[90:91], v[88:89], v[88:89] op_sel_hi:[0,1]
    v_pk_mul_f32 v[94:95], v[92:93], v[92:93] op_sel_hi:[0,1]
    v_pk_fma_f32 v[72:73], v[72:73], v[72:73], v[74:75] op_sel:[1,1,0] op_sel_hi:[1,0,1] neg_lo:[0,1,0]
    v_pk_fma_f32 v[76:77], v[76:77], v[76:77], v[78:79] op_sel:[1,1,0] op_sel_hi:[1,0,1] neg_lo:[0,1,0]
    v_pk_fma_f32 v[88:89], v[88:89], v[88:89], v[90:91] op_sel:[1,1,0] op_sel_hi:[1,0,1] neg_lo:[0,1,0]
    v_pk_fma_f32 v[92:93], v[92:93], v[92:93], v[94:95] op_sel:[1,1,0] op_sel_hi:[1,0,1] neg_lo:[0,1,0]
    v_cvt_pk_bf16_f32 v52, v72, v73
    v_cvt_pk_bf16_f32 v53, v76, v77
    v_cvt_pk_bf16_f32 v54, v88, v89
    v_cvt_pk_bf16_f32 v55, v92, v93
    v_pk_mul_f32 v[74:75], v[72:73], v[72:73] op_sel_hi:[0,1]
    v_pk_mul_f32 v[78:79], v[76:77], v[76:77] op_sel_hi:[0,1]
    v_pk_mul_f32 v[90:91], v[88:89], v[88:89] op_sel_hi:[0,1]
    v_pk_mul_f32 v[94:95], v[92:93], v[92:93] op_sel_hi:[0,1]
    v_pk_fma_f32 v[72:73], v[72:73], v[72:73], v[74:75] op_sel:[1,1,0] op_sel_hi:[1,0,1] neg_lo:[0,1,0]
    v_pk_fma_f32 v[76:77], v[76:77], v[76:77], v[78:79] op_sel:[1,1,0] op_sel_hi:[1,0,1] neg_lo:[0,1,0]
    v_pk_fma_f32 v[88:89], v[88:89], v[88:89], v[90:91] op_sel:[1,1,0] op_sel_hi:[1,0,1] neg_lo:[0,1,0]
    v_pk_fma_f32 v[92:93], v[92:93], v[92:93], v[94:95] op_sel:[1,1,0] op_sel_hi:[1,0,1] neg_lo:[0,1,0]
    v_pk_mul_f32 v[74:75], v[26:27], v[72:73] op_sel_hi:[0,1]
    v_pk_mul_f32 v[78:79], v[30:31], v[76:77] op_sel_hi:[0,1]
    v_pk_mul_f32 v[90:91], v[34:35], v[88:89] op_sel_hi:[0,1]
    v_pk_mul_f32 v[94:95], v[38:39], v[92:93] op_sel_hi:[0,1]
    v_pk_fma_f32 v[74:75], v[26:27], v[72:73], v[74:75] op_sel:[1,1,0] op_sel_hi:[1,0,1] neg_lo:[0,1,0]
    v_pk_fma_f32 v[78:79], v[30:31], v[76:77], v[78:79] op_sel:[1,1,0] op_sel_hi:[1,0,1] neg_lo:[0,1,0]
    v_pk_fma_f32 v[90:91], v[34:35], v[88:89], v[90:91] op_sel:[1,1,0] op_sel_hi:[1,0,1] neg_lo:[0,1,0]
    v_pk_fma_f32 v[94:95], v[38:39], v[92:93], v[94:95] op_sel:[1,1,0] op_sel_hi:[1,0,1] neg_lo:[0,1,0]
    v_cvt_pk_bf16_f32 v56, v74, -v75
    v_cvt_pk_bf16_f32 v57, v78, -v79
    v_cvt_pk_bf16_f32 v58, v90, -v91
    v_cvt_pk_bf16_f32 v59, v94, -v95
    v_pk_mul_f32 v[74:75], v[72:73], v[72:73] op_sel_hi:[0,1]
    v_pk_mul_f32 v[78:79], v[76:77], v[76:77] op_sel_hi:[0,1]
    v_pk_mul_f32 v[90:91], v[88:89], v[88:89] op_sel_hi:[0,1]
    v_pk_mul_f32 v[94:95], v[92:93], v[92:93] op_sel_hi:[0,1]
    v_pk_fma_f32 v[72:73], v[72:73], v[72:73], v[74:75] op_sel:[1,1,0] op_sel_hi:[1,0,1] neg_lo:[0,1,0]
    v_pk_fma_f32 v[76:77], v[76:77], v[76:77], v[78:79] op_sel:[1,1,0] op_sel_hi:[1,0,1] neg_lo:[0,1,0]
    v_pk_fma_f32 v[88:89], v[88:89], v[88:89], v[90:91] op_sel:[1,1,0] op_sel_hi:[1,0,1] neg_lo:[0,1,0]
    v_pk_fma_f32 v[92:93], v[92:93], v[92:93], v[94:95] op_sel:[1,1,0] op_sel_hi:[1,0,1] neg_lo:[0,1,0]
    v_pk_mul_f32 v[74:75], v[26:27], v[72:73] op_sel_hi:[0,1]
    v_pk_mul_f32 v[78:79], v[30:31], v[76:77] op_sel_hi:[0,1]
    v_pk_mul_f32 v[90:91], v[34:35], v[88:89] op_sel_hi:[0,1]
    v_pk_mul_f32 v[94:95], v[38:39], v[92:93] op_sel_hi:[0,1]
    v_pk_fma_f32 v[74:75], v[26:27], v[72:73], v[74:75] op_sel:[1,1,0] op_sel_hi:[1,0,1] neg_lo:[0,1,0]
    v_pk_fma_f32 v[78:79], v[30:31], v[76:77], v[78:79] op_sel:[1,1,0] op_sel_hi:[1,0,1] neg_lo:[0,1,0]
    v_pk_fma_f32 v[90:91], v[34:35], v[88:89], v[90:91] op_sel:[1,1,0] op_sel_hi:[1,0,1] neg_lo:[0,1,0]
    v_pk_fma_f32 v[94:95], v[38:39], v[92:93], v[94:95] op_sel:[1,1,0] op_sel_hi:[1,0,1] neg_lo:[0,1,0]
    v_cvt_pk_bf16_f32 v60, v74, -v75
    v_cvt_pk_bf16_f32 v61, v78, -v79
    v_cvt_pk_bf16_f32 v62, v90, -v91
    v_cvt_pk_bf16_f32 v63, v94, -v95
    v_pk_mul_f32 v[74:75], v[72:73], v[72:73] op_sel_hi:[0,1]
    v_pk_mul_f32 v[78:79], v[76:77], v[76:77] op_sel_hi:[0,1]
    v_pk_mul_f32 v[90:91], v[88:89], v[88:89] op_sel_hi:[0,1]
    v_pk_mul_f32 v[94:95], v[92:93], v[92:93] op_sel_hi:[0,1]
    v_pk_fma_f32 v[72:73], v[72:73], v[72:73], v[74:75] op_sel:[1,1,0] op_sel_hi:[1,0,1] neg_lo:[0,1,0]
    v_pk_fma_f32 v[76:77], v[76:77], v[76:77], v[78:79] op_sel:[1,1,0] op_sel_hi:[1,0,1] neg_lo:[0,1,0]
    v_pk_fma_f32 v[88:89], v[88:89], v[88:89], v[90:91] op_sel:[1,1,0] op_sel_hi:[1,0,1] neg_lo:[0,1,0]
    v_pk_fma_f32 v[92:93], v[92:93], v[92:93], v[94:95] op_sel:[1,1,0] op_sel_hi:[1,0,1] neg_lo:[0,1,0]
    v_pk_mul_f32 v[74:75], v[26:27], v[72:73] op_sel_hi:[0,1]
    v_pk_mul_f32 v[78:79], v[30:31], v[76:77] op_sel_hi:[0,1]
    v_pk_mul_f32 v[90:91], v[34:35], v[88:89] op_sel_hi:[0,1]
    v_pk_mul_f32 v[94:95], v[38:39], v[92:93] op_sel_hi:[0,1]
    v_pk_fma_f32 v[74:75], v[26:27], v[72:73], v[74:75] op_sel:[1,1,0] op_sel_hi:[1,0,1] neg_lo:[0,1,0]
    v_pk_fma_f32 v[78:79], v[30:31], v[76:77], v[78:79] op_sel:[1,1,0] op_sel_hi:[1,0,1] neg_lo:[0,1,0]
    v_pk_fma_f32 v[90:91], v[34:35], v[88:89], v[90:91] op_sel:[1,1,0] op_sel_hi:[1,0,1] neg_lo:[0,1,0]
    v_pk_fma_f32 v[94:95], v[38:39], v[92:93], v[94:95] op_sel:[1,1,0] op_sel_hi:[1,0,1] neg_lo:[0,1,0]
    v_cvt_pk_bf16_f32 v64, v74, -v75
    v_cvt_pk_bf16_f32 v65, v78, -v79
    v_cvt_pk_bf16_f32 v66, v90, -v91
    v_cvt_pk_bf16_f32 v67, v94, -v95
    v_pk_mul_f32 v[74:75], v[72:73], v[72:73] op_sel_hi:[0,1]
    v_pk_mul_f32 v[78:79], v[76:77], v[76:77] op_sel_hi:[0,1]
    v_pk_mul_f32 v[90:91], v[88:89], v[88:89] op_sel_hi:[0,1]
    v_pk_mul_f32 v[94:95], v[92:93], v[92:93] op_sel_hi:[0,1]
    v_pk_fma_f32 v[72:73], v[72:73], v[72:73], v[74:75] op_sel:[1,1,0] op_sel_hi:[1,0,1] neg_lo:[0,1,0]
    v_pk_fma_f32 v[76:77], v[76:77], v[76:77], v[78:79] op_sel:[1,1,0] op_sel_hi:[1,0,1] neg_lo:[0,1,0]
    v_pk_fma_f32 v[88:89], v[88:89], v[88:89], v[90:91] op_sel:[1,1,0] op_sel_hi:[1,0,1] neg_lo:[0,1,0]
    v_pk_fma_f32 v[92:93], v[92:93], v[92:93], v[94:95] op_sel:[1,1,0] op_sel_hi:[1,0,1] neg_lo:[0,1,0]
    v_pk_mul_f32 v[74:75], v[26:27], v[72:73] op_sel_hi:[0,1]
    v_pk_mul_f32 v[78:79], v[30:31], v[76:77] op_sel_hi:[0,1]
    v_pk_mul_f32 v[90:91], v[34:35], v[88:89] op_sel_hi:[0,1]
    v_pk_mul_f32 v[94:95], v[38:39], v[92:93] op_sel_hi:[0,1]
    v_pk_fma_f32 v[74:75], v[26:27], v[72:73], v[74:75] op_sel:[1,1,0] op_sel_hi:[1,0,1] neg_lo:[0,1,0]
    v_pk_fma_f32 v[78:79], v[30:31], v[76:77], v[78:79] op_sel:[1,1,0] op_sel_hi:[1,0,1] neg_lo:[0,1,0]
    v_pk_fma_f32 v[90:91], v[34:35], v[88:89], v[90:91] op_sel:[1,1,0] op_sel_hi:[1,0,1] neg_lo:[0,1,0]
    v_pk_fma_f32 v[94:95], v[38:39], v[92:93], v[94:95] op_sel:[1,1,0] op_sel_hi:[1,0,1] neg_lo:[0,1,0]
    v_cvt_pk_bf16_f32 v68, v74, -v75
    v_cvt_pk_bf16_f32 v69, v78, -v79
    v_cvt_pk_bf16_f32 v70, v90, -v91
    v_cvt_pk_bf16_f32 v71, v94, -v95
    s_nop 1
    v_mfma_f32_16x16x32_bf16 v[96:99], v[40:43], v[56:59], v[96:99]
    v_mfma_f32_16x16x32_bf16 v[100:103], v[44:47], v[60:63], v[100:103]
    v_mfma_f32_16x16x32_bf16 v[104:107], v[48:51], v[64:67], v[104:107]
    v_mfma_f32_16x16x32_bf16 v[108:111], v[52:55], v[68:71], v[108:111]
    v_and_b32 v4, 15, v1
    v_lshlrev_b32 v4, 6, v4
    v_lshrrev_b32 v5, 4, v1
    v_lshl_add_u32 v4, v5, 4, v4
    v_lshl_add_u32 v4, v2, 12, v4
    v_lshlrev_b32 v5, 4, v0
    s_nop 4

    ds_write_b128 v4, v[96:99] offset:2048
    ds_write_b128 v4, v[100:103] offset:3072
    ds_write_b128 v4, v[104:107] offset:4096
    ds_write_b128 v4, v[108:111] offset:5120
    s_waitcnt lgkmcnt(0)
    s_barrier
    ds_read_b128 v[8:11], v5 offset:2048
    ds_read_b128 v[12:15], v5 offset:6144
    ds_read_b128 v[16:19], v5 offset:10240
    ds_read_b128 v[20:23], v5 offset:14336
    v_mov_b32 v26, 0
    ds_read_b64 v[24:25], v26 offset:19968
    v_lshlrev_b32 v4, 3, v1
    v_lshl_add_u32 v4, v2, 8, v4
    v_cmp_gt_u32 vcc, 64, v0
    v_cmp_lt_u32 s[40:41], 31, v1
    s_or_b64 vcc, vcc, s[40:41]
    s_waitcnt lgkmcnt(0)

    v_add_f32 v8, v8, v12
    v_add_f32 v16, v16, v20
    v_add_f32 v9, v9, v13
    v_add_f32 v17, v17, v21
    v_add_f32 v10, v10, v14
    v_add_f32 v18, v18, v22
    v_add_f32 v11, v11, v15
    v_add_f32 v19, v19, v23
    v_add_f32 v8, v8, v16
    v_add_f32 v9, v9, v17
    v_add_f32 v10, v10, v18
    v_add_f32 v11, v11, v19
    v_add_f32 v24, v24, v25
    v_cvt_pk_bf16_f32 v8, v8, v9
    v_cvt_pk_bf16_f32 v9, v10, v11
    v_cvt_pk_bf16_f32 v24, v24, v24
    ds_write_b32 v26, v24 offset:19712
    s_and_saveexec_b64 s[42:43], vcc
    ds_write_b64 v4, v[8:9] offset:18432
    s_mov_b64 exec, s[42:43]
    s_waitcnt lgkmcnt(0)
    s_barrier

    ds_read_u16 v16, v80 offset:18432
    ds_read_u16 v17, v81 offset:18432
    ds_read_u16 v18, v82 offset:18432
    ds_read_u16 v19, v83 offset:18432
    ds_read_u16 v20, v84 offset:18432
    ds_read_u16 v21, v85 offset:18432
    ds_read_u16 v22, v86 offset:18432
    ds_read_u16 v23, v87 offset:18432
    s_mul_i32 s36, s3, 4224
    v_mov_b32 v12, 0
    v_mov_b32 v13, 0
    v_mov_b32 v14, 0
    v_mov_b32 v15, 0
    s_waitcnt lgkmcnt(0)
    v_lshl_or_b32 v8, v17, 16, v16
    v_lshl_or_b32 v9, v19, 16, v18
    v_lshl_or_b32 v10, v21, 16, v20
    v_lshl_or_b32 v11, v23, 16, v22
    buffer_store_dwordx4 v[8:11], v5, s[32:35], s36 offen sc0 sc1

    v_cmp_gt_u32 vcc, 8, v0
    s_and_saveexec_b64 s[42:43], vcc
    s_cbranch_execz K1_END
    s_add_u32 s36, s36, 4096
    buffer_store_dwordx4 v[12:15], v5, s[32:35], s36 offen sc0 sc1
K1_END:
    s_endpgm

.globl k2_kernel
.p2align 8
.type k2_kernel,@function
k2_kernel:
    s_cmp_ge_u32 s2, 432
    s_cbranch_scc1 K2_END
    v_and_b32 v1, 63, v0
    v_lshrrev_b32 v2, 6, v0
    s_mov_b32 s17, 0xffff0000
    s_cmp_ge_u32 s2, 256
    s_cbranch_scc1 K2_W

    s_load_dwordx2 s[4:5], s[0:1], 144
    s_load_dwordx2 s[20:21], s[0:1], 144
    s_load_dwordx2 s[24:25], s[0:1], 64
    s_load_dwordx2 s[12:13], s[0:1], 144
    s_load_dwordx2 s[28:29], s[0:1], 144
    s_waitcnt lgkmcnt(0)
    s_add_u32 s4, s4, 0x1800000
    s_addc_u32 s5, s5, 0
    s_and_b32 s5, s5, 0xffff
    s_mov_b32 s6, 0x410000
    s_mov_b32 s7, 0x00020000
    s_add_u32 s20, s20, 0x300000
    s_addc_u32 s21, s21, 0
    s_and_b32 s21, s21, 0xffff
    s_mov_b32 s22, 0x210000
    s_mov_b32 s23, 0x00020000
    s_add_u32 s28, s28, 0x2000000
    s_addc_u32 s29, s29, 0
    s_and_b32 s29, s29, 0xffff
    s_mov_b32 s30, 0x220000
    s_mov_b32 s31, 0x00020000
    s_mul_i32 s19, s2, 192
    s_add_u32 s19, s19, 2162688
    s_add_u32 s12, s12, s19
    s_addc_u32 s13, s13, 0
    s_lshl_b32 s32, s2, 2
    s_load_dwordx8 s[40:47], s[12:13], 0
    s_load_dwordx4 s[48:51], s[12:13], 32
    s_load_dwordx8 s[52:59], s[12:13], 96
    s_load_dwordx4 s[60:63], s[12:13], 128
    s_load_dword s33, s[24:25], s32
    s_mul_i32 s3, s2, 16640
    v_lshlrev_b32 v4, 6, v0
    v_lshlrev_b32 v3, 5, v0
    v_lshlrev_b32 v5, 4, v0
    s_mul_i32 s16, s2, 8448
    s_add_u32 s18, s16, 4224
    buffer_load_dwordx4 v[8:11], v5, s[20:23], s16 offen
    buffer_load_dwordx2 v[12:13], v5, s[20:23], s16 offen offset:16
    buffer_load_dwordx4 v[16:19], v5, s[20:23], s18 offen
    buffer_load_dwordx2 v[20:21], v5, s[20:23], s18 offen offset:16
    buffer_load_dwordx4 v[104:107], v4, s[4:7], s3 offen offset:0
    buffer_load_dwordx4 v[108:111], v4, s[4:7], s3 offen offset:16
    buffer_load_dwordx4 v[112:115], v4, s[4:7], s3 offen offset:32
    buffer_load_dwordx4 v[116:119], v4, s[4:7], s3 offen offset:48
    s_mul_i32 s3, s2, 8704

    v_mov_b32 v76, 0
    v_mov_b32 v77, 0
    v_mov_b32 v78, 0
    v_mov_b32 v79, 0
    v_cmp_gt_u32 vcc, 144, v0
    s_and_saveexec_b64 s[34:35], vcc
    ds_write_b128 v5, v[76:79] offset:17664
    ds_write_b128 v5, v[76:79] offset:47360
    s_mov_b64 exec, s[34:35]
    v_cmp_gt_u32 vcc, 160, v0
    s_and_saveexec_b64 s[34:35], vcc
    ds_write_b128 v5, v[76:79] offset:24576
    ds_write_b128 v5, v[76:79] offset:54272
    s_mov_b64 exec, s[34:35]
    v_cmp_gt_u32 vcc, 8, v0
    s_and_saveexec_b64 s[34:35], vcc

    ds_write_b128 v5, v[76:79] offset:4096
    ds_write_b128 v5, v[76:79] offset:8512
    ds_write_b128 v5, v[76:79] offset:12928
    ds_write_b128 v5, v[76:79] offset:17344
    ds_write_b128 v5, v[76:79] offset:33792
    ds_write_b128 v5, v[76:79] offset:38208
    ds_write_b128 v5, v[76:79] offset:42624
    ds_write_b128 v5, v[76:79] offset:47040
    s_mov_b64 exec, s[34:35]
    v_and_b32 v92, 31, v1
    v_lshrrev_b32 v93, 5, v1
    v_lshrrev_b32 v94, 1, v2
    v_mul_u32_u24 v94, 29696, v94
    v_sub_u32 v95, 3, v92
    v_and_b32 v95, 3, v95
    v_mul_u32_u24 v96, 4414, v95
    v_add_u32 v96, v96, v94
    v_lshl_add_u32 v96, v93, 4, v96
    v_lshlrev_b32 v97, 1, v92
    v_sub_u32 v96, v96, v97
    v_add_u32 v96, 62, v96
    v_mul_u32_u24 v97, 144, v92
    v_lshl_add_u32 v97, v93, 4, v97
    v_add_u32 v97, v97, v94
    v_mul_u32_u24 v98, 80, v92
    v_lshl_add_u32 v98, v93, 4, v98
    v_add_u32 v98, v98, v94
    v_lshrrev_b32 v99, 3, v0
    v_lshl_add_u32 v99, v99, 4, v5
    v_lshrrev_b32 v100, 2, v0
    v_lshl_add_u32 v100, v100, 4, v5
    s_nop 0
    v_readfirstlane_b32 s36, v2

    s_waitcnt lgkmcnt(0)
    v_mov_b32 v48, s40
    v_mov_b32 v50, s42
    v_add_f32 v48, s41, v48
    v_add_f32 v50, s43, v50
    v_add_f32 v48, v48, v50
    v_mov_b32 v56, s44
    v_mov_b32 v58, s46
    v_add_f32 v56, s45, v56
    v_add_f32 v58, s47, v58
    v_add_f32 v56, v56, v58
    v_mov_b32 v64, s48
    v_mov_b32 v66, s50
    v_add_f32 v64, s49, v64
    v_add_f32 v66, s51, v66
    v_add_f32 v64, v64, v66
    v_mov_b32 v49, s52
    v_mov_b32 v51, s54
    v_add_f32 v49, s53, v49
    v_add_f32 v51, s55, v51
    v_add_f32 v49, v49, v51
    v_mov_b32 v57, s56
    v_mov_b32 v59, s58
    v_add_f32 v57, s57, v57
    v_add_f32 v59, s59, v59
    v_add_f32 v57, v57, v59
    v_mov_b32 v65, s60
    v_mov_b32 v67, s62
    v_add_f32 v65, s61, v65
    v_add_f32 v67, s63, v67
    v_add_f32 v65, v65, v67
    v_cvt_pk_bf16_f32 v48, v48, v49
    v_cvt_pk_bf16_f32 v56, v56, v57
    v_cvt_pk_bf16_f32 v64, v64, v65
    v_and_b32 v49, s17, v48
    v_lshlrev_b32 v48, 16, v48
    v_and_b32 v57, s17, v56
    v_lshlrev_b32 v56, 16, v56
    v_and_b32 v65, s17, v64
    v_lshlrev_b32 v64, 16, v64
    v_add_f32 v56, 1.0, v56
    v_add_f32 v57, 1.0, v57
    v_cvt_pk_bf16_f32 v56, v56, v57
    v_and_b32 v57, s17, v56
    v_lshlrev_b32 v56, 16, v56
    v_mov_b32 v72, s33
    v_and_b32 v73, s17, v72
    v_lshlrev_b32 v72, 16, v72
    s_waitcnt vmcnt(6)
    ds_write_b128 v5, v[8:11] offset:0
    v_alignbit_b32 v80, v9, v8, 16
    v_alignbit_b32 v81, v10, v9, 16
    v_alignbit_b32 v82, v11, v10, 16
    v_alignbit_b32 v83, v12, v11, 16
    v_mov_b32 v84, v9
    v_mov_b32 v85, v10
    v_mov_b32 v86, v11
    v_mov_b32 v87, v12
    v_alignbit_b32 v88, v10, v9, 16
    v_alignbit_b32 v89, v11, v10, 16
    v_alignbit_b32 v90, v12, v11, 16
    v_alignbit_b32 v91, v13, v12, 16
    ds_write_b128 v5, v[80:83] offset:4416
    ds_write_b128 v5, v[84:87] offset:8832
    ds_write_b128 v5, v[88:91] offset:13248
    s_nop 1
    s_waitcnt vmcnt(4)
    ds_write_b128 v5, v[16:19] offset:29696
    v_alignbit_b32 v80, v17, v16, 16
    v_alignbit_b32 v81, v18, v17, 16
    v_alignbit_b32 v82, v19, v18, 16
    v_alignbit_b32 v83, v20, v19, 16
    v_mov_b32 v84, v17
    v_mov_b32 v85, v18
    v_mov_b32 v86, v19
    v_mov_b32 v87, v20
    v_alignbit_b32 v88, v18, v17, 16
    v_alignbit_b32 v89, v19, v18, 16
    v_alignbit_b32 v90, v20, v19, 16
    v_alignbit_b32 v91, v21, v20, 16
    ds_write_b128 v5, v[80:83] offset:34112
    ds_write_b128 v5, v[84:87] offset:38528
    ds_write_b128 v5, v[88:91] offset:42944
    s_waitcnt vmcnt(0)
    v_lshlrev_b32 v120, 16, v105
    v_and_b32 v128, s17, v105
    v_lshlrev_b32 v121, 16, v107
    v_and_b32 v129, s17, v107
    v_lshlrev_b32 v122, 16, v109
    v_and_b32 v130, s17, v109
    v_lshlrev_b32 v123, 16, v111
    v_and_b32 v131, s17, v111
    v_lshlrev_b32 v124, 16, v113
    v_and_b32 v132, s17, v113
    v_lshlrev_b32 v125, 16, v115
    v_and_b32 v133, s17, v115
    v_lshlrev_b32 v126, 16, v117
    v_and_b32 v134, s17, v117
    v_lshlrev_b32 v127, 16, v119
    v_and_b32 v135, s17, v119
    v_mul_f32 v120, v120, v56
    v_mul_f32 v121, v121, v56
    v_mul_f32 v122, v122, v56
    v_mul_f32 v123, v123, v56
    v_mul_f32 v124, v124, v56
    v_mul_f32 v125, v125, v56
    v_mul_f32 v126, v126, v56
    v_mul_f32 v127, v127, v56
    v_mul_f32 v128, v128, v57
    v_mul_f32 v129, v129, v57
    v_mul_f32 v130, v130, v57
    v_mul_f32 v131, v131, v57
    v_mul_f32 v132, v132, v57
    v_mul_f32 v133, v133, v57
    v_mul_f32 v134, v134, v57
    v_mul_f32 v135, v135, v57
    v_cvt_pk_bf16_f32 v120, v120, v121
    v_cvt_pk_bf16_f32 v122, v122, v123
    v_cvt_pk_bf16_f32 v124, v124, v125
    v_cvt_pk_bf16_f32 v126, v126, v127
    v_cvt_pk_bf16_f32 v128, v128, v129
    v_cvt_pk_bf16_f32 v130, v130, v131
    v_cvt_pk_bf16_f32 v132, v132, v133
    v_cvt_pk_bf16_f32 v134, v134, v135
    v_and_b32 v121, s17, v120
    v_lshlrev_b32 v120, 16, v120
    v_and_b32 v123, s17, v122
    v_lshlrev_b32 v122, 16, v122
    v_and_b32 v125, s17, v124
    v_lshlrev_b32 v124, 16, v124
    v_and_b32 v127, s17, v126
    v_lshlrev_b32 v126, 16, v126
    v_and_b32 v129, s17, v128
    v_lshlrev_b32 v128, 16, v128
    v_and_b32 v131, s17, v130
    v_lshlrev_b32 v130, 16, v130
    v_and_b32 v133, s17, v132
    v_lshlrev_b32 v132, 16, v132
    v_and_b32 v135, s17, v134
    v_lshlrev_b32 v134, 16, v134
    v_add_f32 v120, v120, v48
    v_add_f32 v121, v121, v48
    v_add_f32 v122, v122, v48
    v_add_f32 v123, v123, v48
    v_add_f32 v124, v124, v48
    v_add_f32 v125, v125, v48
    v_add_f32 v126, v126, v48
    v_add_f32 v127, v127, v48
    v_add_f32 v128, v128, v49
    v_add_f32 v129, v129, v49
    v_add_f32 v130, v130, v49
    v_add_f32 v131, v131, v49
    v_add_f32 v132, v132, v49
    v_add_f32 v133, v133, v49
    v_add_f32 v134, v134, v49
    v_add_f32 v135, v135, v49
    v_cvt_pk_bf16_f32 v224, v120, v121
    v_cvt_pk_bf16_f32 v225, v122, v123
    v_cvt_pk_bf16_f32 v226, v124, v125
    v_cvt_pk_bf16_f32 v227, v126, v127
    v_cvt_pk_bf16_f32 v228, v128, v129
    v_cvt_pk_bf16_f32 v229, v130, v131
    v_cvt_pk_bf16_f32 v230, v132, v133
    v_cvt_pk_bf16_f32 v231, v134, v135
    ds_write_b128 v99, v[224:227] offset:19968
    ds_write_b128 v99, v[228:231] offset:49664
    v_cmp_gt_u32 vcc, 128, v0
    s_and_saveexec_b64 s[34:35], vcc
    ds_write_b128 v100, v[224:227] offset:27136
    ds_write_b128 v100, v[228:231] offset:56832
    s_mov_b64 exec, s[34:35]
    s_waitcnt lgkmcnt(0)
    s_barrier
    s_bitcmp1_b32 s36, 0
    s_cbranch_scc1 K2_R1

    ds_read_b64 v[8:9], v96 offset:4064
    ds_read_b64 v[10:11], v96 offset:4072
    ds_read_b128 v[184:187], v97 offset:20064
    ds_read_b128 v[188:191], v97 offset:20000
    ds_read_b64 v[12:13], v96 offset:4032
    ds_read_b64 v[14:15], v96 offset:4040
    ds_read_b128 v[192:195], v97 offset:20032
    ds_read_b128 v[196:199], v97 offset:19968
    ds_read_b64 v[16:17], v96 offset:4000
    ds_read_b64 v[18:19], v96 offset:4008
    ds_read_b128 v[200:203], v97 offset:19920
    ds_read_b64 v[20:21], v96 offset:3968
    ds_read_b64 v[22:23], v96 offset:3976
    ds_read_b128 v[204:207], v97 offset:19888
    ds_read_b64 v[24:25], v96 offset:3936
    ds_read_b64 v[26:27], v96 offset:3944
    ds_read_b128 v[208:211], v97 offset:19856
    s_waitcnt lgkmcnt(13)
    v_mfma_f32_32x32x16_bf16 v[136:151], v[8:11], v[188:191], 0
    v_lshlrev_b32 v120, 16, v224
    v_mfma_f32_32x32x16_bf16 v[152:167], v[8:11], v[184:187], 0
    v_and_b32 v121, s17, v224
    ds_read_b64 v[28:29], v96 offset:3904
    ds_read_b64 v[30:31], v96 offset:3912
    ds_read_b128 v[212:215], v97 offset:19824
    s_waitcnt lgkmcnt(12)
    v_mfma_f32_32x32x16_bf16 v[136:151], v[12:15], v[196:199], v[136:151]
    v_lshlrev_b32 v122, 16, v225
    v_mfma_f32_32x32x16_bf16 v[152:167], v[12:15], v[192:195], v[152:167]
    v_and_b32 v123, s17, v225
    ds_read_b64 v[32:33], v96 offset:3872
    ds_read_b64 v[34:35], v96 offset:3880
    ds_read_b128 v[216:219], v97 offset:19776
    s_waitcnt lgkmcnt(12)
    v_mfma_f32_32x32x16_bf16 v[136:151], v[16:19], v[200:203], v[136:151]
    v_lshlrev_b32 v124, 16, v226
    v_mfma_f32_32x32x16_bf16 v[152:167], v[16:19], v[188:191], v[152:167]
    v_and_b32 v125, s17, v226
    ds_read_b64 v[36:37], v96 offset:3840
    ds_read_b64 v[38:39], v96 offset:3848
    ds_read_b128 v[220:223], v97 offset:19744
    s_waitcnt lgkmcnt(12)
    v_mfma_f32_32x32x16_bf16 v[136:151], v[20:23], v[204:207], v[136:151]
    v_lshlrev_b32 v126, 16, v227
    v_mfma_f32_32x32x16_bf16 v[152:167], v[20:23], v[196:199], v[152:167]
    v_and_b32 v127, s17, v227
    ds_read_b64 v[8:9], v96 offset:3808
    ds_read_b64 v[10:11], v96 offset:3816
    ds_read_b128 v[184:187], v97 offset:19712
    s_waitcnt lgkmcnt(12)
    v_mfma_f32_32x32x16_bf16 v[136:151], v[24:27], v[208:211], v[136:151]
    v_lshlrev_b32 v128, 16, v228
    v_mfma_f32_32x32x16_bf16 v[152:167], v[24:27], v[200:203], v[152:167]
    v_and_b32 v129, s17, v228
    ds_read_b64 v[12:13], v96 offset:3776
    ds_read_b64 v[14:15], v96 offset:3784
    ds_read_b128 v[188:191], v97 offset:19680
    s_waitcnt lgkmcnt(12)
    v_mfma_f32_32x32x16_bf16 v[136:151], v[28:31], v[212:215], v[136:151]
    v_lshlrev_b32 v130, 16, v229
    v_mfma_f32_32x32x16_bf16 v[152:167], v[28:31], v[204:207], v[152:167]
    v_and_b32 v131, s17, v229
    ds_read_b64 v[16:17], v96 offset:3744
    ds_read_b64 v[18:19], v96 offset:3752
    ds_read_b128 v[192:195], v97 offset:19632
    s_waitcnt lgkmcnt(12)
    v_mfma_f32_32x32x16_bf16 v[136:151], v[32:35], v[216:219], v[136:151]
    v_lshlrev_b32 v132, 16, v230
    v_mfma_f32_32x32x16_bf16 v[152:167], v[32:35], v[208:211], v[152:167]
    v_and_b32 v133, s17, v230
    ds_read_b64 v[20:21], v96 offset:3712
    ds_read_b64 v[22:23], v96 offset:3720
    ds_read_b128 v[196:199], v97 offset:19600
    s_waitcnt lgkmcnt(12)
    v_mfma_f32_32x32x16_bf16 v[136:151], v[36:39], v[220:223], v[136:151]
    v_lshlrev_b32 v134, 16, v231
    v_mfma_f32_32x32x16_bf16 v[152:167], v[36:39], v[212:215], v[152:167]
    v_and_b32 v135, s17, v231
    ds_read_b64 v[24:25], v96 offset:3680
    ds_read_b64 v[26:27], v96 offset:3688
    ds_read_b128 v[200:203], v97 offset:19568
    s_waitcnt lgkmcnt(12)
    v_mfma_f32_32x32x16_bf16 v[136:151], v[8:11], v[184:187], v[136:151]
    v_mul_f32 v120, v120, v72
    v_mfma_f32_32x32x16_bf16 v[152:167], v[8:11], v[216:219], v[152:167]
    v_mul_f32 v121, v121, v72
    ds_read_b64 v[28:29], v96 offset:3648
    ds_read_b64 v[30:31], v96 offset:3656
    ds_read_b128 v[204:207], v97 offset:19536
    s_waitcnt lgkmcnt(12)
    v_mfma_f32_32x32x16_bf16 v[136:151], v[12:15], v[188:191], v[136:151]
    v_mul_f32 v122, v122, v72
    v_mfma_f32_32x32x16_bf16 v[152:167], v[12:15], v[220:223], v[152:167]
    v_mul_f32 v123, v123, v72
    ds_read_b64 v[32:33], v96 offset:3616
    ds_read_b64 v[34:35], v96 offset:3624
    ds_read_b128 v[208:211], v97 offset:19488
    s_waitcnt lgkmcnt(12)
    v_mfma_f32_32x32x16_bf16 v[136:151], v[16:19], v[192:195], v[136:151]
    v_mul_f32 v124, v124, v72
    v_mfma_f32_32x32x16_bf16 v[152:167], v[16:19], v[184:187], v[152:167]
    v_mul_f32 v125, v125, v72
    ds_read_b64 v[36:37], v96 offset:3584
    ds_read_b64 v[38:39], v96 offset:3592
    ds_read_b128 v[212:215], v97 offset:19456
    s_waitcnt lgkmcnt(12)
    v_mfma_f32_32x32x16_bf16 v[136:151], v[20:23], v[196:199], v[136:151]
    v_mul_f32 v126, v126, v72
    v_mfma_f32_32x32x16_bf16 v[152:167], v[20:23], v[188:191], v[152:167]
    v_mul_f32 v127, v127, v72
    ds_read_b64 v[8:9], v96 offset:3552
    ds_read_b64 v[10:11], v96 offset:3560
    ds_read_b128 v[216:219], v97 offset:19424
    s_waitcnt lgkmcnt(12)
    v_mfma_f32_32x32x16_bf16 v[136:151], v[24:27], v[200:203], v[136:151]
    v_mul_f32 v128, v128, v73
    v_mfma_f32_32x32x16_bf16 v[152:167], v[24:27], v[192:195], v[152:167]
    v_mul_f32 v129, v129, v73
    ds_read_b64 v[12:13], v96 offset:3520
    ds_read_b64 v[14:15], v96 offset:3528
    ds_read_b128 v[220:223], v97 offset:19392
    s_waitcnt lgkmcnt(12)
    v_mfma_f32_32x32x16_bf16 v[136:151], v[28:31], v[204:207], v[136:151]
    v_mul_f32 v130, v130, v73
    v_mfma_f32_32x32x16_bf16 v[152:167], v[28:31], v[196:199], v[152:167]
    v_mul_f32 v131, v131, v73
    ds_read_b64 v[16:17], v96 offset:3488
    ds_read_b64 v[18:19], v96 offset:3496
    ds_read_b128 v[184:187], v97 offset:19344
    s_waitcnt lgkmcnt(12)
    v_mfma_f32_32x32x16_bf16 v[136:151], v[32:35], v[208:211], v[136:151]
    v_mul_f32 v132, v132, v73
    v_mfma_f32_32x32x16_bf16 v[152:167], v[32:35], v[200:203], v[152:167]
    v_mul_f32 v133, v133, v73
    ds_read_b64 v[20:21], v96 offset:3456
    ds_read_b64 v[22:23], v96 offset:3464
    ds_read_b128 v[188:191], v97 offset:19312
    s_waitcnt lgkmcnt(12)
    v_mfma_f32_32x32x16_bf16 v[136:151], v[36:39], v[212:215], v[136:151]
    v_mul_f32 v134, v134, v73
    v_mfma_f32_32x32x16_bf16 v[152:167], v[36:39], v[204:207], v[152:167]
    v_mul_f32 v135, v135, v73
    ds_read_b64 v[24:25], v96 offset:3424
    ds_read_b64 v[26:27], v96 offset:3432
    ds_read_b128 v[192:195], v97 offset:19280
    s_waitcnt lgkmcnt(12)
    v_mfma_f32_32x32x16_bf16 v[136:151], v[8:11], v[216:219], v[136:151]
    v_cvt_pk_bf16_f32 v120, v120, v121
    v_mfma_f32_32x32x16_bf16 v[152:167], v[8:11], v[208:211], v[152:167]
    v_cvt_pk_bf16_f32 v122, v122, v123
    ds_read_b64 v[28:29], v96 offset:3392
    ds_read_b64 v[30:31], v96 offset:3400
    ds_read_b128 v[196:199], v97 offset:19248
    s_waitcnt lgkmcnt(12)
    v_mfma_f32_32x32x16_bf16 v[136:151], v[12:15], v[220:223], v[136:151]
    v_cvt_pk_bf16_f32 v124, v124, v125
    v_mfma_f32_32x32x16_bf16 v[152:167], v[12:15], v[212:215], v[152:167]
    v_cvt_pk_bf16_f32 v126, v126, v127
    ds_read_b64 v[32:33], v96 offset:3360
    ds_read_b64 v[34:35], v96 offset:3368
    ds_read_b128 v[200:203], v97 offset:19200
    s_waitcnt lgkmcnt(12)
    v_mfma_f32_32x32x16_bf16 v[136:151], v[16:19], v[184:187], v[136:151]
    v_cvt_pk_bf16_f32 v128, v128, v129
    v_mfma_f32_32x32x16_bf16 v[152:167], v[16:19], v[216:219], v[152:167]
    v_cvt_pk_bf16_f32 v130, v130, v131
    ds_read_b64 v[36:37], v96 offset:3328
    ds_read_b64 v[38:39], v96 offset:3336
    ds_read_b128 v[204:207], v97 offset:19168
    s_waitcnt lgkmcnt(12)
    v_mfma_f32_32x32x16_bf16 v[136:151], v[20:23], v[188:191], v[136:151]
    v_cvt_pk_bf16_f32 v132, v132, v133
    v_mfma_f32_32x32x16_bf16 v[152:167], v[20:23], v[220:223], v[152:167]
    v_cvt_pk_bf16_f32 v134, v134, v135
    ds_read_b64 v[8:9], v96 offset:3296
    ds_read_b64 v[10:11], v96 offset:3304
    ds_read_b128 v[208:211], v97 offset:19136
    s_waitcnt lgkmcnt(12)
    v_mfma_f32_32x32x16_bf16 v[136:151], v[24:27], v[192:195], v[136:151]
    v_and_b32 v121, s17, v120
    v_mfma_f32_32x32x16_bf16 v[152:167], v[24:27], v[184:187], v[152:167]
    v_lshlrev_b32 v120, 16, v120
    ds_read_b64 v[12:13], v96 offset:3264
    ds_read_b64 v[14:15], v96 offset:3272
    ds_read_b128 v[212:215], v97 offset:19104
    s_waitcnt lgkmcnt(12)
    v_mfma_f32_32x32x16_bf16 v[136:151], v[28:31], v[196:199], v[136:151]
    v_and_b32 v123, s17, v122
    v_mfma_f32_32x32x16_bf16 v[152:167], v[28:31], v[188:191], v[152:167]
    v_lshlrev_b32 v122, 16, v122
    ds_read_b64 v[16:17], v96 offset:3232
    ds_read_b64 v[18:19], v96 offset:3240
    ds_read_b128 v[216:219], v97 offset:19056
    s_waitcnt lgkmcnt(12)
    v_mfma_f32_32x32x16_bf16 v[136:151], v[32:35], v[200:203], v[136:151]
    v_and_b32 v125, s17, v124
    v_mfma_f32_32x32x16_bf16 v[152:167], v[32:35], v[192:195], v[152:167]
    v_lshlrev_b32 v124, 16, v124
    ds_read_b64 v[20:21], v96 offset:3200
    ds_read_b64 v[22:23], v96 offset:3208
    ds_read_b128 v[220:223], v97 offset:19024
    s_waitcnt lgkmcnt(12)
    v_mfma_f32_32x32x16_bf16 v[136:151], v[36:39], v[204:207], v[136:151]
    v_and_b32 v127, s17, v126
    v_mfma_f32_32x32x16_bf16 v[152:167], v[36:39], v[196:199], v[152:167]
    v_lshlrev_b32 v126, 16, v126
    ds_read_b64 v[24:25], v96 offset:3168
    ds_read_b64 v[26:27], v96 offset:3176
    ds_read_b128 v[184:187], v97 offset:18992
    s_waitcnt lgkmcnt(12)
    v_mfma_f32_32x32x16_bf16 v[136:151], v[8:11], v[208:211], v[136:151]
    v_and_b32 v129, s17, v128
    v_mfma_f32_32x32x16_bf16 v[152:167], v[8:11], v[200:203], v[152:167]
    v_lshlrev_b32 v128, 16, v128
    ds_read_b64 v[28:29], v96 offset:3136
    ds_read_b64 v[30:31], v96 offset:3144
    ds_read_b128 v[188:191], v97 offset:18960
    s_waitcnt lgkmcnt(12)
    v_mfma_f32_32x32x16_bf16 v[136:151], v[12:15], v[212:215], v[136:151]
    v_and_b32 v131, s17, v130
    v_mfma_f32_32x32x16_bf16 v[152:167], v[12:15], v[204:207], v[152:167]
    v_lshlrev_b32 v130, 16, v130
    ds_read_b64 v[32:33], v96 offset:3104
    ds_read_b64 v[34:35], v96 offset:3112
    ds_read_b128 v[192:195], v97 offset:18912
    s_waitcnt lgkmcnt(12)
    v_mfma_f32_32x32x16_bf16 v[136:151], v[16:19], v[216:219], v[136:151]
    v_and_b32 v133, s17, v132
    v_mfma_f32_32x32x16_bf16 v[152:167], v[16:19], v[208:211], v[152:167]
    v_lshlrev_b32 v132, 16, v132
    ds_read_b64 v[36:37], v96 offset:3072
    ds_read_b64 v[38:39], v96 offset:3080
    ds_read_b128 v[196:199], v97 offset:18880
    s_waitcnt lgkmcnt(12)
    v_mfma_f32_32x32x16_bf16 v[136:151], v[20:23], v[220:223], v[136:151]
    v_and_b32 v135, s17, v134
    v_mfma_f32_32x32x16_bf16 v[152:167], v[20:23], v[212:215], v[152:167]
    v_lshlrev_b32 v134, 16, v134
    ds_read_b64 v[8:9], v96 offset:3040
    ds_read_b64 v[10:11], v96 offset:3048
    ds_read_b128 v[200:203], v97 offset:18848
    s_waitcnt lgkmcnt(12)
    v_mfma_f32_32x32x16_bf16 v[136:151], v[24:27], v[184:187], v[136:151]
    v_and_b32 v105, s17, v104
    v_mfma_f32_32x32x16_bf16 v[152:167], v[24:27], v[216:219], v[152:167]
    v_lshlrev_b32 v104, 16, v104
    ds_read_b64 v[12:13], v96 offset:3008
    ds_read_b64 v[14:15], v96 offset:3016
    ds_read_b128 v[204:207], v97 offset:18816
    s_waitcnt lgkmcnt(12)
    v_mfma_f32_32x32x16_bf16 v[136:151], v[28:31], v[188:191], v[136:151]
    v_and_b32 v107, s17, v106
    v_mfma_f32_32x32x16_bf16 v[152:167], v[28:31], v[220:223], v[152:167]
    v_lshlrev_b32 v106, 16, v106
    ds_read_b64 v[16:17], v96 offset:2976
    ds_read_b64 v[18:19], v96 offset:2984
    ds_read_b128 v[208:211], v97 offset:18768
    s_waitcnt lgkmcnt(12)
    v_mfma_f32_32x32x16_bf16 v[136:151], v[32:35], v[192:195], v[136:151]
    v_and_b32 v109, s17, v108
    v_mfma_f32_32x32x16_bf16 v[152:167], v[32:35], v[184:187], v[152:167]
    v_lshlrev_b32 v108, 16, v108
    ds_read_b64 v[20:21], v96 offset:2944
    ds_read_b64 v[22:23], v96 offset:2952
    ds_read_b128 v[212:215], v97 offset:18736
    s_waitcnt lgkmcnt(12)
    v_mfma_f32_32x32x16_bf16 v[136:151], v[36:39], v[196:199], v[136:151]
    v_and_b32 v111, s17, v110
    v_mfma_f32_32x32x16_bf16 v[152:167], v[36:39], v[188:191], v[152:167]
    v_lshlrev_b32 v110, 16, v110
    ds_read_b64 v[24:25], v96 offset:2912
    ds_read_b64 v[26:27], v96 offset:2920
    ds_read_b128 v[216:219], v97 offset:18704
    s_waitcnt lgkmcnt(12)
    v_mfma_f32_32x32x16_bf16 v[136:151], v[8:11], v[200:203], v[136:151]
    v_and_b32 v113, s17, v112
    v_mfma_f32_32x32x16_bf16 v[152:167], v[8:11], v[192:195], v[152:167]
    v_lshlrev_b32 v112, 16, v112
    ds_read_b64 v[28:29], v96 offset:2880
    ds_read_b64 v[30:31], v96 offset:2888
    ds_read_b128 v[220:223], v97 offset:18672
    s_waitcnt lgkmcnt(12)
    v_mfma_f32_32x32x16_bf16 v[136:151], v[12:15], v[204:207], v[136:151]
    v_and_b32 v115, s17, v114
    v_mfma_f32_32x32x16_bf16 v[152:167], v[12:15], v[196:199], v[152:167]
    v_lshlrev_b32 v114, 16, v114
    ds_read_b64 v[32:33], v96 offset:2848
    ds_read_b64 v[34:35], v96 offset:2856
    ds_read_b128 v[184:187], v97 offset:18624
    s_waitcnt lgkmcnt(12)
    v_mfma_f32_32x32x16_bf16 v[136:151], v[16:19], v[208:211], v[136:151]
    v_and_b32 v117, s17, v116
    v_mfma_f32_32x32x16_bf16 v[152:167], v[16:19], v[200:203], v[152:167]
    v_lshlrev_b32 v116, 16, v116
    ds_read_b64 v[36:37], v96 offset:2816
    ds_read_b64 v[38:39], v96 offset:2824
    ds_read_b128 v[188:191], v97 offset:18592
    s_waitcnt lgkmcnt(12)
    v_mfma_f32_32x32x16_bf16 v[136:151], v[20:23], v[212:215], v[136:151]
    v_and_b32 v119, s17, v118
    v_mfma_f32_32x32x16_bf16 v[152:167], v[20:23], v[204:207], v[152:167]
    v_lshlrev_b32 v118, 16, v118
    ds_read_b64 v[8:9], v96 offset:2784
    ds_read_b64 v[10:11], v96 offset:2792
    ds_read_b128 v[192:195], v97 offset:18560
    s_waitcnt lgkmcnt(12)
    v_mfma_f32_32x32x16_bf16 v[136:151], v[24:27], v[216:219], v[136:151]
    v_mfma_f32_32x32x16_bf16 v[152:167], v[24:27], v[208:211], v[152:167]
    ds_read_b64 v[12:13], v96 offset:2752
    ds_read_b64 v[14:15], v96 offset:2760
    ds_read_b128 v[196:199], v97 offset:18528
    s_waitcnt lgkmcnt(12)
    v_mfma_f32_32x32x16_bf16 v[136:151], v[28:31], v[220:223], v[136:151]
    v_mfma_f32_32x32x16_bf16 v[152:167], v[28:31], v[212:215], v[152:167]
    ds_read_b64 v[16:17], v96 offset:2720
    ds_read_b64 v[18:19], v96 offset:2728
    ds_read_b128 v[200:203], v97 offset:18480
    s_waitcnt lgkmcnt(12)
    v_mfma_f32_32x32x16_bf16 v[136:151], v[32:35], v[184:187], v[136:151]
    v_mfma_f32_32x32x16_bf16 v[152:167], v[32:35], v[216:219], v[152:167]
    ds_read_b64 v[20:21], v96 offset:2688
    ds_read_b64 v[22:23], v96 offset:2696
    ds_read_b128 v[204:207], v97 offset:18448
    s_waitcnt lgkmcnt(12)
    v_mfma_f32_32x32x16_bf16 v[136:151], v[36:39], v[188:191], v[136:151]
    v_mfma_f32_32x32x16_bf16 v[152:167], v[36:39], v[220:223], v[152:167]
    ds_read_b64 v[24:25], v96 offset:2656
    ds_read_b64 v[26:27], v96 offset:2664
    ds_read_b128 v[208:211], v97 offset:18416
    s_waitcnt lgkmcnt(12)
    v_mfma_f32_32x32x16_bf16 v[136:151], v[8:11], v[192:195], v[136:151]
    v_mfma_f32_32x32x16_bf16 v[152:167], v[8:11], v[184:187], v[152:167]
    ds_read_b64 v[28:29], v96 offset:2624
    ds_read_b64 v[30:31], v96 offset:2632
    ds_read_b128 v[212:215], v97 offset:18384
    s_waitcnt lgkmcnt(12)
    v_mfma_f32_32x32x16_bf16 v[136:151], v[12:15], v[196:199], v[136:151]
    v_mfma_f32_32x32x16_bf16 v[152:167], v[12:15], v[188:191], v[152:167]
    ds_read_b64 v[32:33], v96 offset:2592
    ds_read_b64 v[34:35], v96 offset:2600
    ds_read_b128 v[216:219], v97 offset:18336
    s_waitcnt lgkmcnt(12)
    v_mfma_f32_32x32x16_bf16 v[136:151], v[16:19], v[200:203], v[136:151]
    v_mfma_f32_32x32x16_bf16 v[152:167], v[16:19], v[192:195], v[152:167]
    ds_read_b64 v[36:37], v96 offset:2560
    ds_read_b64 v[38:39], v96 offset:2568
    ds_read_b128 v[220:223], v97 offset:18304
    s_waitcnt lgkmcnt(12)
    v_mfma_f32_32x32x16_bf16 v[136:151], v[20:23], v[204:207], v[136:151]
    v_mfma_f32_32x32x16_bf16 v[152:167], v[20:23], v[196:199], v[152:167]
    s_waitcnt lgkmcnt(9)
    v_mfma_f32_32x32x16_bf16 v[136:151], v[24:27], v[208:211], v[136:151]
    v_mfma_f32_32x32x16_bf16 v[152:167], v[24:27], v[200:203], v[152:167]
    s_waitcnt lgkmcnt(6)
    v_mfma_f32_32x32x16_bf16 v[136:151], v[28:31], v[212:215], v[136:151]
    v_mfma_f32_32x32x16_bf16 v[152:167], v[28:31], v[204:207], v[152:167]
    s_waitcnt lgkmcnt(3)
    v_mfma_f32_32x32x16_bf16 v[136:151], v[32:35], v[216:219], v[136:151]
    v_mfma_f32_32x32x16_bf16 v[152:167], v[32:35], v[208:211], v[152:167]
    s_waitcnt lgkmcnt(0)
    v_mfma_f32_32x32x16_bf16 v[136:151], v[36:39], v[220:223], v[136:151]
    v_mfma_f32_32x32x16_bf16 v[152:167], v[36:39], v[212:215], v[152:167]
    v_mul_u32_u24 v97, 272, v92
    v_lshl_add_u32 v97, v93, 4, v97
    v_add_u32 v97, v97, v94
    v_mul_u32_u24 v98, 144, v92
    v_lshl_add_u32 v98, v93, 4, v98
    v_add_u32 v98, v98, v94
    s_nop 7
    s_barrier

    ds_write_b128 v97, v[136:139] offset:8704
    ds_write_b128 v97, v[140:143] offset:8736
    ds_write_b128 v97, v[144:147] offset:8768
    ds_write_b128 v97, v[148:151] offset:8800
    ds_write_b128 v97, v[152:155] offset:8832
    ds_write_b128 v97, v[156:159] offset:8864
    ds_write_b128 v97, v[160:163] offset:8896
    ds_write_b128 v97, v[164:167] offset:8928
    s_branch K2_EP
K2_R1:
    ds_read_b64 v[8:9], v96 offset:2528
    ds_read_b64 v[10:11], v96 offset:2536
    ds_read_b128 v[184:187], v97 offset:18336
    ds_read_b128 v[188:191], v97 offset:18272
    ds_read_b64 v[12:13], v96 offset:2496
    ds_read_b64 v[14:15], v96 offset:2504
    ds_read_b128 v[192:195], v97 offset:18304
    ds_read_b128 v[196:199], v97 offset:18240
    ds_read_b64 v[16:17], v96 offset:2464
    ds_read_b64 v[18:19], v96 offset:2472
    ds_read_b128 v[200:203], v97 offset:18192
    ds_read_b64 v[20:21], v96 offset:2432
    ds_read_b64 v[22:23], v96 offset:2440
    ds_read_b128 v[204:207], v97 offset:18160
    ds_read_b64 v[24:25], v96 offset:2400
    ds_read_b64 v[26:27], v96 offset:2408
    ds_read_b128 v[208:211], v97 offset:18128
    s_waitcnt lgkmcnt(13)
    v_mfma_f32_32x32x16_bf16 v[136:151], v[8:11], v[188:191], 0
    v_lshlrev_b32 v120, 16, v224
    v_mfma_f32_32x32x16_bf16 v[152:167], v[8:11], v[184:187], 0
    v_and_b32 v121, s17, v224
    ds_read_b64 v[28:29], v96 offset:2368
    ds_read_b64 v[30:31], v96 offset:2376
    ds_read_b128 v[212:215], v97 offset:18096
    s_waitcnt lgkmcnt(12)
    v_mfma_f32_32x32x16_bf16 v[136:151], v[12:15], v[196:199], v[136:151]
    v_lshlrev_b32 v122, 16, v225
    v_mfma_f32_32x32x16_bf16 v[152:167], v[12:15], v[192:195], v[152:167]
    v_and_b32 v123, s17, v225
    ds_read_b64 v[32:33], v96 offset:2336
    ds_read_b64 v[34:35], v96 offset:2344
    ds_read_b128 v[216:219], v97 offset:18048
    s_waitcnt lgkmcnt(12)
    v_mfma_f32_32x32x16_bf16 v[136:151], v[16:19], v[200:203], v[136:151]
    v_lshlrev_b32 v124, 16, v226
    v_mfma_f32_32x32x16_bf16 v[152:167], v[16:19], v[188:191], v[152:167]
    v_and_b32 v125, s17, v226
    ds_read_b64 v[36:37], v96 offset:2304
    ds_read_b64 v[38:39], v96 offset:2312
    ds_read_b128 v[220:223], v97 offset:18016
    s_waitcnt lgkmcnt(12)
    v_mfma_f32_32x32x16_bf16 v[136:151], v[20:23], v[204:207], v[136:151]
    v_lshlrev_b32 v126, 16, v227
    v_mfma_f32_32x32x16_bf16 v[152:167], v[20:23], v[196:199], v[152:167]
    v_and_b32 v127, s17, v227
    ds_read_b64 v[8:9], v96 offset:2272
    ds_read_b64 v[10:11], v96 offset:2280
    ds_read_b128 v[184:187], v97 offset:17984
    s_waitcnt lgkmcnt(12)
    v_mfma_f32_32x32x16_bf16 v[136:151], v[24:27], v[208:211], v[136:151]
    v_lshlrev_b32 v128, 16, v228
    v_mfma_f32_32x32x16_bf16 v[152:167], v[24:27], v[200:203], v[152:167]
    v_and_b32 v129, s17, v228
    ds_read_b64 v[12:13], v96 offset:2240
    ds_read_b64 v[14:15], v96 offset:2248
    ds_read_b128 v[188:191], v97 offset:17952
    s_waitcnt lgkmcnt(12)
    v_mfma_f32_32x32x16_bf16 v[136:151], v[28:31], v[212:215], v[136:151]
    v_lshlrev_b32 v130, 16, v229
    v_mfma_f32_32x32x16_bf16 v[152:167], v[28:31], v[204:207], v[152:167]
    v_and_b32 v131, s17, v229
    ds_read_b64 v[16:17], v96 offset:2208
    ds_read_b64 v[18:19], v96 offset:2216
    ds_read_b128 v[192:195], v97 offset:17904
    s_waitcnt lgkmcnt(12)
    v_mfma_f32_32x32x16_bf16 v[136:151], v[32:35], v[216:219], v[136:151]
    v_lshlrev_b32 v132, 16, v230
    v_mfma_f32_32x32x16_bf16 v[152:167], v[32:35], v[208:211], v[152:167]
    v_and_b32 v133, s17, v230
    ds_read_b64 v[20:21], v96 offset:2176
    ds_read_b64 v[22:23], v96 offset:2184
    ds_read_b128 v[196:199], v97 offset:17872
    s_waitcnt lgkmcnt(12)
    v_mfma_f32_32x32x16_bf16 v[136:151], v[36:39], v[220:223], v[136:151]
    v_lshlrev_b32 v134, 16, v231
    v_mfma_f32_32x32x16_bf16 v[152:167], v[36:39], v[212:215], v[152:167]
    v_and_b32 v135, s17, v231
    ds_read_b64 v[24:25], v96 offset:2144
    ds_read_b64 v[26:27], v96 offset:2152
    ds_read_b128 v[200:203], v97 offset:17840
    s_waitcnt lgkmcnt(12)
    v_mfma_f32_32x32x16_bf16 v[136:151], v[8:11], v[184:187], v[136:151]
    v_mul_f32 v120, v120, v72
    v_mfma_f32_32x32x16_bf16 v[152:167], v[8:11], v[216:219], v[152:167]
    v_mul_f32 v121, v121, v72
    ds_read_b64 v[28:29], v96 offset:2112
    ds_read_b64 v[30:31], v96 offset:2120
    ds_read_b128 v[204:207], v97 offset:17808
    s_waitcnt lgkmcnt(12)
    v_mfma_f32_32x32x16_bf16 v[136:151], v[12:15], v[188:191], v[136:151]
    v_mul_f32 v122, v122, v72
    v_mfma_f32_32x32x16_bf16 v[152:167], v[12:15], v[220:223], v[152:167]
    v_mul_f32 v123, v123, v72
    ds_read_b64 v[32:33], v96 offset:2080
    ds_read_b64 v[34:35], v96 offset:2088
    ds_read_b128 v[208:211], v97 offset:17760
    s_waitcnt lgkmcnt(12)
    v_mfma_f32_32x32x16_bf16 v[136:151], v[16:19], v[192:195], v[136:151]
    v_mul_f32 v124, v124, v72
    v_mfma_f32_32x32x16_bf16 v[152:167], v[16:19], v[184:187], v[152:167]
    v_mul_f32 v125, v125, v72
    ds_read_b64 v[36:37], v96 offset:2048
    ds_read_b64 v[38:39], v96 offset:2056
    ds_read_b128 v[212:215], v97 offset:17728
    s_waitcnt lgkmcnt(12)
    v_mfma_f32_32x32x16_bf16 v[136:151], v[20:23], v[196:199], v[136:151]
    v_mul_f32 v126, v126, v72
    v_mfma_f32_32x32x16_bf16 v[152:167], v[20:23], v[188:191], v[152:167]
    v_mul_f32 v127, v127, v72
    ds_read_b64 v[8:9], v96 offset:2016
    ds_read_b64 v[10:11], v96 offset:2024
    ds_read_b128 v[216:219], v97 offset:17696
    s_waitcnt lgkmcnt(12)
    v_mfma_f32_32x32x16_bf16 v[136:151], v[24:27], v[200:203], v[136:151]
    v_mul_f32 v128, v128, v73
    v_mfma_f32_32x32x16_bf16 v[152:167], v[24:27], v[192:195], v[152:167]
    v_mul_f32 v129, v129, v73
    ds_read_b64 v[12:13], v96 offset:1984
    ds_read_b64 v[14:15], v96 offset:1992
    ds_read_b128 v[220:223], v98 offset:27136
    s_waitcnt lgkmcnt(12)
    v_mfma_f32_32x32x16_bf16 v[136:151], v[28:31], v[204:207], v[136:151]
    v_mul_f32 v130, v130, v73
    v_mfma_f32_32x32x16_bf16 v[152:167], v[28:31], v[196:199], v[152:167]
    v_mul_f32 v131, v131, v73
    ds_read_b64 v[16:17], v96 offset:1952
    ds_read_b64 v[18:19], v96 offset:1960
    ds_read_b128 v[184:187], v98 offset:27088
    s_waitcnt lgkmcnt(12)
    v_mfma_f32_32x32x16_bf16 v[136:151], v[32:35], v[208:211], v[136:151]
    v_mul_f32 v132, v132, v73
    v_mfma_f32_32x32x16_bf16 v[152:167], v[32:35], v[200:203], v[152:167]
    v_mul_f32 v133, v133, v73
    ds_read_b64 v[20:21], v96 offset:1920
    ds_read_b64 v[22:23], v96 offset:1928
    ds_read_b128 v[188:191], v98 offset:27056
    s_waitcnt lgkmcnt(12)
    v_mfma_f32_32x32x16_bf16 v[136:151], v[36:39], v[212:215], v[136:151]
    v_mul_f32 v134, v134, v73
    v_mfma_f32_32x32x16_bf16 v[152:167], v[36:39], v[204:207], v[152:167]
    v_mul_f32 v135, v135, v73
    ds_read_b64 v[24:25], v96 offset:1888
    ds_read_b64 v[26:27], v96 offset:1896
    ds_read_b128 v[192:195], v98 offset:27008
    s_waitcnt lgkmcnt(12)
    v_mfma_f32_32x32x16_bf16 v[136:151], v[8:11], v[216:219], v[136:151]
    v_cvt_pk_bf16_f32 v120, v120, v121
    v_mfma_f32_32x32x16_bf16 v[152:167], v[8:11], v[208:211], v[152:167]
    v_cvt_pk_bf16_f32 v122, v122, v123
    ds_read_b64 v[28:29], v96 offset:1856
    ds_read_b64 v[30:31], v96 offset:1864
    ds_read_b128 v[196:199], v98 offset:26976
    s_waitcnt lgkmcnt(12)
    v_mfma_f32_32x32x16_bf16 v[168:183], v[12:15], v[220:223], 0
    v_cvt_pk_bf16_f32 v124, v124, v125
    ds_read_b64 v[32:33], v96 offset:1824
    ds_read_b64 v[34:35], v96 offset:1832
    ds_read_b128 v[200:203], v98 offset:26928
    s_waitcnt lgkmcnt(12)
    v_mfma_f32_32x32x16_bf16 v[168:183], v[16:19], v[184:187], v[168:183]
    v_cvt_pk_bf16_f32 v126, v126, v127
    ds_read_b64 v[36:37], v96 offset:1792
    ds_read_b64 v[38:39], v96 offset:1800
    ds_read_b128 v[204:207], v98 offset:26896
    s_waitcnt lgkmcnt(12)
    v_mfma_f32_32x32x16_bf16 v[168:183], v[20:23], v[188:191], v[168:183]
    v_cvt_pk_bf16_f32 v128, v128, v129
    ds_read_b64 v[8:9], v96 offset:1760
    ds_read_b64 v[10:11], v96 offset:1768
    ds_read_b128 v[208:211], v98 offset:26848
    s_waitcnt lgkmcnt(12)
    v_mfma_f32_32x32x16_bf16 v[168:183], v[24:27], v[192:195], v[168:183]
    v_cvt_pk_bf16_f32 v130, v130, v131
    ds_read_b64 v[12:13], v96 offset:1728
    ds_read_b64 v[14:15], v96 offset:1736
    ds_read_b128 v[212:215], v98 offset:26816
    s_waitcnt lgkmcnt(12)
    v_mfma_f32_32x32x16_bf16 v[168:183], v[28:31], v[196:199], v[168:183]
    v_cvt_pk_bf16_f32 v132, v132, v133
    ds_read_b64 v[16:17], v96 offset:1696
    ds_read_b64 v[18:19], v96 offset:1704
    ds_read_b128 v[216:219], v98 offset:26768
    s_waitcnt lgkmcnt(12)
    v_mfma_f32_32x32x16_bf16 v[168:183], v[32:35], v[200:203], v[168:183]
    v_cvt_pk_bf16_f32 v134, v134, v135
    ds_read_b64 v[20:21], v96 offset:1664
    ds_read_b64 v[22:23], v96 offset:1672
    ds_read_b128 v[220:223], v98 offset:26736
    s_waitcnt lgkmcnt(12)
    v_mfma_f32_32x32x16_bf16 v[168:183], v[36:39], v[204:207], v[168:183]
    v_and_b32 v121, s17, v120
    ds_read_b64 v[24:25], v96 offset:1632
    ds_read_b64 v[26:27], v96 offset:1640
    ds_read_b128 v[184:187], v98 offset:26688
    s_waitcnt lgkmcnt(12)
    v_mfma_f32_32x32x16_bf16 v[168:183], v[8:11], v[208:211], v[168:183]
    v_lshlrev_b32 v120, 16, v120
    ds_read_b64 v[28:29], v96 offset:1600
    ds_read_b64 v[30:31], v96 offset:1608
    ds_read_b128 v[188:191], v98 offset:26656
    s_waitcnt lgkmcnt(12)
    v_mfma_f32_32x32x16_bf16 v[168:183], v[12:15], v[212:215], v[168:183]
    v_and_b32 v123, s17, v122
    ds_read_b64 v[32:33], v96 offset:1568
    ds_read_b64 v[34:35], v96 offset:1576
    ds_read_b128 v[192:195], v98 offset:26608
    s_waitcnt lgkmcnt(12)
    v_mfma_f32_32x32x16_bf16 v[168:183], v[16:19], v[216:219], v[168:183]
    v_lshlrev_b32 v122, 16, v122
    ds_read_b64 v[36:37], v96 offset:1536
    ds_read_b64 v[38:39], v96 offset:1544
    ds_read_b128 v[196:199], v98 offset:26576
    s_waitcnt lgkmcnt(12)
    v_mfma_f32_32x32x16_bf16 v[168:183], v[20:23], v[220:223], v[168:183]
    v_and_b32 v125, s17, v124
    ds_read_b64 v[8:9], v96 offset:1504
    ds_read_b64 v[10:11], v96 offset:1512
    ds_read_b128 v[200:203], v98 offset:26528
    s_waitcnt lgkmcnt(12)
    v_mfma_f32_32x32x16_bf16 v[168:183], v[24:27], v[184:187], v[168:183]
    v_lshlrev_b32 v124, 16, v124
    ds_read_b64 v[12:13], v96 offset:1472
    ds_read_b64 v[14:15], v96 offset:1480
    ds_read_b128 v[204:207], v98 offset:26496
    s_waitcnt lgkmcnt(12)
    v_mfma_f32_32x32x16_bf16 v[168:183], v[28:31], v[188:191], v[168:183]
    v_and_b32 v127, s17, v126
    ds_read_b64 v[16:17], v96 offset:1440
    ds_read_b64 v[18:19], v96 offset:1448
    ds_read_b128 v[208:211], v98 offset:26448
    s_waitcnt lgkmcnt(12)
    v_mfma_f32_32x32x16_bf16 v[168:183], v[32:35], v[192:195], v[168:183]
    v_lshlrev_b32 v126, 16, v126
    ds_read_b64 v[20:21], v96 offset:1408
    ds_read_b64 v[22:23], v96 offset:1416
    ds_read_b128 v[212:215], v98 offset:26416
    s_waitcnt lgkmcnt(12)
    v_mfma_f32_32x32x16_bf16 v[168:183], v[36:39], v[196:199], v[168:183]
    v_and_b32 v129, s17, v128
    ds_read_b64 v[24:25], v96 offset:1376
    ds_read_b64 v[26:27], v96 offset:1384
    ds_read_b128 v[216:219], v98 offset:26368
    s_waitcnt lgkmcnt(12)
    v_mfma_f32_32x32x16_bf16 v[168:183], v[8:11], v[200:203], v[168:183]
    v_lshlrev_b32 v128, 16, v128
    ds_read_b64 v[28:29], v96 offset:1344
    ds_read_b64 v[30:31], v96 offset:1352
    ds_read_b128 v[220:223], v98 offset:26336
    s_waitcnt lgkmcnt(12)
    v_mfma_f32_32x32x16_bf16 v[168:183], v[12:15], v[204:207], v[168:183]
    v_and_b32 v131, s17, v130
    ds_read_b64 v[32:33], v96 offset:1312
    ds_read_b64 v[34:35], v96 offset:1320
    ds_read_b128 v[184:187], v98 offset:26288
    s_waitcnt lgkmcnt(12)
    v_mfma_f32_32x32x16_bf16 v[168:183], v[16:19], v[208:211], v[168:183]
    v_lshlrev_b32 v130, 16, v130
    ds_read_b64 v[36:37], v96 offset:1280
    ds_read_b64 v[38:39], v96 offset:1288
    ds_read_b128 v[188:191], v98 offset:26256
    s_waitcnt lgkmcnt(12)
    v_mfma_f32_32x32x16_bf16 v[168:183], v[20:23], v[212:215], v[168:183]
    v_and_b32 v133, s17, v132
    ds_read_b64 v[8:9], v96 offset:1248
    ds_read_b64 v[10:11], v96 offset:1256
    ds_read_b128 v[192:195], v98 offset:26208
    s_waitcnt lgkmcnt(12)
    v_mfma_f32_32x32x16_bf16 v[168:183], v[24:27], v[216:219], v[168:183]
    v_lshlrev_b32 v132, 16, v132
    ds_read_b64 v[12:13], v96 offset:1216
    ds_read_b64 v[14:15], v96 offset:1224
    ds_read_b128 v[196:199], v98 offset:26176
    s_waitcnt lgkmcnt(12)
    v_mfma_f32_32x32x16_bf16 v[168:183], v[28:31], v[220:223], v[168:183]
    v_and_b32 v135, s17, v134
    ds_read_b64 v[16:17], v96 offset:1184
    ds_read_b64 v[18:19], v96 offset:1192
    ds_read_b128 v[200:203], v98 offset:26128
    s_waitcnt lgkmcnt(12)
    v_mfma_f32_32x32x16_bf16 v[168:183], v[32:35], v[184:187], v[168:183]
    v_lshlrev_b32 v134, 16, v134
    ds_read_b64 v[20:21], v96 offset:1152
    ds_read_b64 v[22:23], v96 offset:1160
    ds_read_b128 v[204:207], v98 offset:26096
    s_waitcnt lgkmcnt(12)
    v_mfma_f32_32x32x16_bf16 v[168:183], v[36:39], v[188:191], v[168:183]
    v_and_b32 v105, s17, v104
    ds_read_b64 v[24:25], v96 offset:1120
    ds_read_b64 v[26:27], v96 offset:1128
    ds_read_b128 v[208:211], v98 offset:26048
    s_waitcnt lgkmcnt(12)
    v_mfma_f32_32x32x16_bf16 v[168:183], v[8:11], v[192:195], v[168:183]
    v_lshlrev_b32 v104, 16, v104
    ds_read_b64 v[28:29], v96 offset:1088
    ds_read_b64 v[30:31], v96 offset:1096
    ds_read_b128 v[212:215], v98 offset:26016
    s_waitcnt lgkmcnt(12)
    v_mfma_f32_32x32x16_bf16 v[168:183], v[12:15], v[196:199], v[168:183]
    v_and_b32 v107, s17, v106
    ds_read_b64 v[32:33], v96 offset:1056
    ds_read_b64 v[34:35], v96 offset:1064
    ds_read_b128 v[216:219], v98 offset:25968
    s_waitcnt lgkmcnt(12)
    v_mfma_f32_32x32x16_bf16 v[168:183], v[16:19], v[200:203], v[168:183]
    v_lshlrev_b32 v106, 16, v106
    ds_read_b64 v[36:37], v96 offset:1024
    ds_read_b64 v[38:39], v96 offset:1032
    ds_read_b128 v[220:223], v98 offset:25936
    s_waitcnt lgkmcnt(12)
    v_mfma_f32_32x32x16_bf16 v[168:183], v[20:23], v[204:207], v[168:183]
    v_and_b32 v109, s17, v108
    ds_read_b64 v[8:9], v96 offset:992
    ds_read_b64 v[10:11], v96 offset:1000
    ds_read_b128 v[184:187], v98 offset:25888
    s_waitcnt lgkmcnt(12)
    v_mfma_f32_32x32x16_bf16 v[168:183], v[24:27], v[208:211], v[168:183]
    v_lshlrev_b32 v108, 16, v108
    ds_read_b64 v[12:13], v96 offset:960
    ds_read_b64 v[14:15], v96 offset:968
    ds_read_b128 v[188:191], v98 offset:25856
    s_waitcnt lgkmcnt(12)
    v_mfma_f32_32x32x16_bf16 v[168:183], v[28:31], v[212:215], v[168:183]
    v_and_b32 v111, s17, v110
    ds_read_b64 v[16:17], v96 offset:928
    ds_read_b64 v[18:19], v96 offset:936
    ds_read_b128 v[192:195], v98 offset:25808
    s_waitcnt lgkmcnt(12)
    v_mfma_f32_32x32x16_bf16 v[168:183], v[32:35], v[216:219], v[168:183]
    v_lshlrev_b32 v110, 16, v110
    ds_read_b64 v[20:21], v96 offset:896
    ds_read_b64 v[22:23], v96 offset:904
    ds_read_b128 v[196:199], v98 offset:25776
    s_waitcnt lgkmcnt(12)
    v_mfma_f32_32x32x16_bf16 v[168:183], v[36:39], v[220:223], v[168:183]
    v_and_b32 v113, s17, v112
    ds_read_b64 v[24:25], v96 offset:864
    ds_read_b64 v[26:27], v96 offset:872
    ds_read_b128 v[200:203], v98 offset:25728
    s_waitcnt lgkmcnt(12)
    v_mfma_f32_32x32x16_bf16 v[168:183], v[8:11], v[184:187], v[168:183]
    v_lshlrev_b32 v112, 16, v112
    ds_read_b64 v[28:29], v96 offset:832
    ds_read_b64 v[30:31], v96 offset:840
    ds_read_b128 v[204:207], v98 offset:25696
    s_waitcnt lgkmcnt(12)
    v_mfma_f32_32x32x16_bf16 v[168:183], v[12:15], v[188:191], v[168:183]
    v_and_b32 v115, s17, v114
    ds_read_b64 v[32:33], v96 offset:800
    ds_read_b64 v[34:35], v96 offset:808
    ds_read_b128 v[208:211], v98 offset:25648
    s_waitcnt lgkmcnt(12)
    v_mfma_f32_32x32x16_bf16 v[168:183], v[16:19], v[192:195], v[168:183]
    v_lshlrev_b32 v114, 16, v114
    ds_read_b64 v[36:37], v96 offset:768
    ds_read_b64 v[38:39], v96 offset:776
    ds_read_b128 v[212:215], v98 offset:25616
    s_waitcnt lgkmcnt(12)
    v_mfma_f32_32x32x16_bf16 v[168:183], v[20:23], v[196:199], v[168:183]
    v_and_b32 v117, s17, v116
    ds_read_b64 v[8:9], v96 offset:736
    ds_read_b64 v[10:11], v96 offset:744
    ds_read_b128 v[216:219], v98 offset:25568
    s_waitcnt lgkmcnt(12)
    v_mfma_f32_32x32x16_bf16 v[168:183], v[24:27], v[200:203], v[168:183]
    v_lshlrev_b32 v116, 16, v116
    ds_read_b64 v[12:13], v96 offset:704
    ds_read_b64 v[14:15], v96 offset:712
    ds_read_b128 v[220:223], v98 offset:25536
    s_waitcnt lgkmcnt(12)
    v_mfma_f32_32x32x16_bf16 v[168:183], v[28:31], v[204:207], v[168:183]
    v_and_b32 v119, s17, v118
    ds_read_b64 v[16:17], v96 offset:672
    ds_read_b64 v[18:19], v96 offset:680
    ds_read_b128 v[184:187], v98 offset:25488
    s_waitcnt lgkmcnt(12)
    v_mfma_f32_32x32x16_bf16 v[168:183], v[32:35], v[208:211], v[168:183]
    v_lshlrev_b32 v118, 16, v118
    ds_read_b64 v[20:21], v96 offset:640
    ds_read_b64 v[22:23], v96 offset:648
    ds_read_b128 v[188:191], v98 offset:25456
    s_waitcnt lgkmcnt(12)
    v_mfma_f32_32x32x16_bf16 v[168:183], v[36:39], v[212:215], v[168:183]
    ds_read_b64 v[24:25], v96 offset:608
    ds_read_b64 v[26:27], v96 offset:616
    ds_read_b128 v[192:195], v98 offset:25408
    s_waitcnt lgkmcnt(12)
    v_mfma_f32_32x32x16_bf16 v[168:183], v[8:11], v[216:219], v[168:183]
    ds_read_b64 v[28:29], v96 offset:576
    ds_read_b64 v[30:31], v96 offset:584
    ds_read_b128 v[196:199], v98 offset:25376
    s_waitcnt lgkmcnt(12)
    v_mfma_f32_32x32x16_bf16 v[168:183], v[12:15], v[220:223], v[168:183]
    ds_read_b64 v[32:33], v96 offset:544
    ds_read_b64 v[34:35], v96 offset:552
    ds_read_b128 v[200:203], v98 offset:25328
    s_waitcnt lgkmcnt(12)
    v_mfma_f32_32x32x16_bf16 v[168:183], v[16:19], v[184:187], v[168:183]
    ds_read_b64 v[36:37], v96 offset:512
    ds_read_b64 v[38:39], v96 offset:520
    ds_read_b128 v[204:207], v98 offset:25296
    s_waitcnt lgkmcnt(12)
    v_mfma_f32_32x32x16_bf16 v[168:183], v[20:23], v[188:191], v[168:183]
    ds_read_b64 v[8:9], v96 offset:480
    ds_read_b64 v[10:11], v96 offset:488
    ds_read_b128 v[208:211], v98 offset:25248
    s_waitcnt lgkmcnt(12)
    v_mfma_f32_32x32x16_bf16 v[168:183], v[24:27], v[192:195], v[168:183]
    ds_read_b64 v[12:13], v96 offset:448
    ds_read_b64 v[14:15], v96 offset:456
    ds_read_b128 v[212:215], v98 offset:25216
    s_waitcnt lgkmcnt(12)
    v_mfma_f32_32x32x16_bf16 v[168:183], v[28:31], v[196:199], v[168:183]
    ds_read_b64 v[16:17], v96 offset:416
    ds_read_b64 v[18:19], v96 offset:424
    ds_read_b128 v[216:219], v98 offset:25168
    s_waitcnt lgkmcnt(12)
    v_mfma_f32_32x32x16_bf16 v[168:183], v[32:35], v[200:203], v[168:183]
    ds_read_b64 v[20:21], v96 offset:384
    ds_read_b64 v[22:23], v96 offset:392
    ds_read_b128 v[220:223], v98 offset:25136
    s_waitcnt lgkmcnt(12)
    v_mfma_f32_32x32x16_bf16 v[168:183], v[36:39], v[204:207], v[168:183]
    ds_read_b64 v[24:25], v96 offset:352
    ds_read_b64 v[26:27], v96 offset:360
    ds_read_b128 v[184:187], v98 offset:25088
    s_waitcnt lgkmcnt(12)
    v_mfma_f32_32x32x16_bf16 v[168:183], v[8:11], v[208:211], v[168:183]
    ds_read_b64 v[28:29], v96 offset:320
    ds_read_b64 v[30:31], v96 offset:328
    ds_read_b128 v[188:191], v98 offset:25056
    s_waitcnt lgkmcnt(12)
    v_mfma_f32_32x32x16_bf16 v[168:183], v[12:15], v[212:215], v[168:183]
    ds_read_b64 v[32:33], v96 offset:288
    ds_read_b64 v[34:35], v96 offset:296
    ds_read_b128 v[192:195], v98 offset:25008
    s_waitcnt lgkmcnt(12)
    v_mfma_f32_32x32x16_bf16 v[168:183], v[16:19], v[216:219], v[168:183]
    ds_read_b64 v[36:37], v96 offset:256
    ds_read_b64 v[38:39], v96 offset:264
    ds_read_b128 v[196:199], v98 offset:24976
    s_waitcnt lgkmcnt(12)
    v_mfma_f32_32x32x16_bf16 v[168:183], v[20:23], v[220:223], v[168:183]
    ds_read_b64 v[8:9], v96 offset:224
    ds_read_b64 v[10:11], v96 offset:232
    ds_read_b128 v[200:203], v98 offset:24928
    s_waitcnt lgkmcnt(12)
    v_mfma_f32_32x32x16_bf16 v[168:183], v[24:27], v[184:187], v[168:183]
    ds_read_b64 v[12:13], v96 offset:192
    ds_read_b64 v[14:15], v96 offset:200
    ds_read_b128 v[204:207], v98 offset:24896
    s_waitcnt lgkmcnt(12)
    v_mfma_f32_32x32x16_bf16 v[168:183], v[28:31], v[188:191], v[168:183]
    ds_read_b64 v[16:17], v96 offset:160
    ds_read_b64 v[18:19], v96 offset:168
    ds_read_b128 v[208:211], v98 offset:24848
    s_waitcnt lgkmcnt(12)
    v_mfma_f32_32x32x16_bf16 v[168:183], v[32:35], v[192:195], v[168:183]
    ds_read_b64 v[20:21], v96 offset:128
    ds_read_b64 v[22:23], v96 offset:136
    ds_read_b128 v[212:215], v98 offset:24816
    s_waitcnt lgkmcnt(12)
    v_mfma_f32_32x32x16_bf16 v[168:183], v[36:39], v[196:199], v[168:183]
    ds_read_b64 v[24:25], v96 offset:96
    ds_read_b64 v[26:27], v96 offset:104
    ds_read_b128 v[216:219], v98 offset:24768
    s_waitcnt lgkmcnt(12)
    v_mfma_f32_32x32x16_bf16 v[168:183], v[8:11], v[200:203], v[168:183]
    ds_read_b64 v[28:29], v96 offset:64
    ds_read_b64 v[30:31], v96 offset:72
    ds_read_b128 v[220:223], v98 offset:24736
    s_waitcnt lgkmcnt(12)
    v_mfma_f32_32x32x16_bf16 v[168:183], v[12:15], v[204:207], v[168:183]
    ds_read_b64 v[32:33], v96 offset:32
    ds_read_b64 v[34:35], v96 offset:40
    ds_read_b128 v[184:187], v98 offset:24688
    s_waitcnt lgkmcnt(12)
    v_mfma_f32_32x32x16_bf16 v[168:183], v[16:19], v[208:211], v[168:183]
    ds_read_b64 v[36:37], v96 offset:0
    ds_read_b64 v[38:39], v96 offset:8
    ds_read_b128 v[188:191], v98 offset:24656
    s_waitcnt lgkmcnt(12)
    v_mfma_f32_32x32x16_bf16 v[168:183], v[20:23], v[212:215], v[168:183]
    s_waitcnt lgkmcnt(9)
    v_mfma_f32_32x32x16_bf16 v[168:183], v[24:27], v[216:219], v[168:183]
    s_waitcnt lgkmcnt(6)
    v_mfma_f32_32x32x16_bf16 v[168:183], v[28:31], v[220:223], v[168:183]
    s_waitcnt lgkmcnt(3)
    v_mfma_f32_32x32x16_bf16 v[168:183], v[32:35], v[184:187], v[168:183]
    s_waitcnt lgkmcnt(0)
    v_mfma_f32_32x32x16_bf16 v[168:183], v[36:39], v[188:191], v[168:183]
    v_mul_u32_u24 v97, 272, v92
    v_lshl_add_u32 v97, v93, 4, v97
    v_add_u32 v97, v97, v94
    v_mul_u32_u24 v98, 144, v92
    v_lshl_add_u32 v98, v93, 4, v98
    v_add_u32 v98, v98, v94
    s_nop 7
    s_barrier

    ds_write_b128 v97, v[136:139] offset:0
    ds_write_b128 v97, v[140:143] offset:32
    ds_write_b128 v97, v[144:147] offset:64
    ds_write_b128 v97, v[148:151] offset:96
    ds_write_b128 v97, v[152:155] offset:128
    ds_write_b128 v97, v[156:159] offset:160
    ds_write_b128 v97, v[160:163] offset:192
    ds_write_b128 v97, v[164:167] offset:224
    ds_write_b128 v98, v[168:171] offset:17408
    ds_write_b128 v98, v[172:175] offset:17440
    ds_write_b128 v98, v[176:179] offset:17472
    ds_write_b128 v98, v[180:183] offset:17504
K2_EP:
    v_lshrrev_b32 v99, 3, v0
    v_lshl_add_u32 v99, v99, 4, v3
    v_and_b32 v100, 127, v0
    v_lshrrev_b32 v101, 2, v100
    v_lshlrev_b32 v100, 5, v100
    v_lshl_add_u32 v100, v101, 4, v100
    s_waitcnt lgkmcnt(0)
    s_barrier

    ds_read_b128 v[8:11], v99 offset:0
    ds_read_b128 v[24:27], v99 offset:8704
    ds_read_b128 v[136:139], v100 offset:17408
    ds_read_b128 v[12:15], v99 offset:16
    ds_read_b128 v[28:31], v99 offset:8720
    ds_read_b128 v[140:143], v100 offset:17424
    ds_read_b128 v[16:19], v99 offset:29696
    ds_read_b128 v[32:35], v99 offset:38400
    ds_read_b128 v[144:147], v100 offset:47104
    ds_read_b128 v[20:23], v99 offset:29712
    ds_read_b128 v[36:39], v99 offset:38416
    ds_read_b128 v[148:151], v100 offset:47120
    s_waitcnt lgkmcnt(0)
    s_cmp_lt_u32 s36, 2
    s_cbranch_scc1 K2_NOB
    v_pk_add_f32 v[8:9], v[8:9], v[136:137]
    v_pk_add_f32 v[10:11], v[10:11], v[138:139]
    v_pk_add_f32 v[12:13], v[12:13], v[140:141]
    v_pk_add_f32 v[14:15], v[14:15], v[142:143]
    v_pk_add_f32 v[16:17], v[16:17], v[144:145]
    v_pk_add_f32 v[18:19], v[18:19], v[146:147]
    v_pk_add_f32 v[20:21], v[20:21], v[148:149]
    v_pk_add_f32 v[22:23], v[22:23], v[150:151]
K2_NOB:
    v_pk_add_f32 v[8:9], v[8:9], v[24:25]
    v_pk_add_f32 v[10:11], v[10:11], v[26:27]
    v_pk_add_f32 v[12:13], v[12:13], v[28:29]
    v_pk_add_f32 v[14:15], v[14:15], v[30:31]
    v_pk_add_f32 v[16:17], v[16:17], v[32:33]
    v_pk_add_f32 v[18:19], v[18:19], v[34:35]
    v_pk_add_f32 v[20:21], v[20:21], v[36:37]
    v_pk_add_f32 v[22:23], v[22:23], v[38:39]
    v_cvt_pk_bf16_f32 v8, v8, v9
    v_cvt_pk_bf16_f32 v10, v10, v11
    v_cvt_pk_bf16_f32 v12, v12, v13
    v_cvt_pk_bf16_f32 v14, v14, v15
    v_cvt_pk_bf16_f32 v16, v16, v17
    v_cvt_pk_bf16_f32 v18, v18, v19
    v_cvt_pk_bf16_f32 v20, v20, v21
    v_cvt_pk_bf16_f32 v22, v22, v23
    v_and_b32 v9, s17, v8
    v_lshlrev_b32 v8, 16, v8
    v_and_b32 v11, s17, v10
    v_lshlrev_b32 v10, 16, v10
    v_and_b32 v13, s17, v12
    v_lshlrev_b32 v12, 16, v12
    v_and_b32 v15, s17, v14
    v_lshlrev_b32 v14, 16, v14
    v_and_b32 v17, s17, v16
    v_lshlrev_b32 v16, 16, v16
    v_and_b32 v19, s17, v18
    v_lshlrev_b32 v18, 16, v18
    v_and_b32 v21, s17, v20
    v_lshlrev_b32 v20, 16, v20
    v_and_b32 v23, s17, v22
    v_lshlrev_b32 v22, 16, v22
    v_pk_add_f32 v[8:9], v[8:9], v[120:121]
    v_pk_add_f32 v[10:11], v[10:11], v[122:123]
    v_pk_add_f32 v[12:13], v[12:13], v[124:125]
    v_pk_add_f32 v[14:15], v[14:15], v[126:127]
    v_pk_add_f32 v[16:17], v[16:17], v[128:129]
    v_pk_add_f32 v[18:19], v[18:19], v[130:131]
    v_pk_add_f32 v[20:21], v[20:21], v[132:133]
    v_pk_add_f32 v[22:23], v[22:23], v[134:135]
    v_cvt_pk_bf16_f32 v8, v8, v9
    v_cvt_pk_bf16_f32 v10, v10, v11
    v_cvt_pk_bf16_f32 v12, v12, v13
    v_cvt_pk_bf16_f32 v14, v14, v15
    v_cvt_pk_bf16_f32 v16, v16, v17
    v_cvt_pk_bf16_f32 v18, v18, v19
    v_cvt_pk_bf16_f32 v20, v20, v21
    v_cvt_pk_bf16_f32 v22, v22, v23
    v_and_b32 v9, s17, v8
    v_lshlrev_b32 v8, 16, v8
    v_and_b32 v11, s17, v10
    v_lshlrev_b32 v10, 16, v10
    v_and_b32 v13, s17, v12
    v_lshlrev_b32 v12, 16, v12
    v_and_b32 v15, s17, v14
    v_lshlrev_b32 v14, 16, v14
    v_and_b32 v17, s17, v16
    v_lshlrev_b32 v16, 16, v16
    v_and_b32 v19, s17, v18
    v_lshlrev_b32 v18, 16, v18
    v_and_b32 v21, s17, v20
    v_lshlrev_b32 v20, 16, v20
    v_and_b32 v23, s17, v22
    v_lshlrev_b32 v22, 16, v22
    v_pk_mul_f32 v[8:9], v[8:9], v[64:65] op_sel:[0,0] op_sel_hi:[1,0]
    v_pk_mul_f32 v[10:11], v[10:11], v[64:65] op_sel:[0,0] op_sel_hi:[1,0]
    v_pk_mul_f32 v[12:13], v[12:13], v[64:65] op_sel:[0,0] op_sel_hi:[1,0]
    v_pk_mul_f32 v[14:15], v[14:15], v[64:65] op_sel:[0,0] op_sel_hi:[1,0]
    v_pk_mul_f32 v[16:17], v[16:17], v[64:65] op_sel:[0,1] op_sel_hi:[1,1]
    v_pk_mul_f32 v[18:19], v[18:19], v[64:65] op_sel:[0,1] op_sel_hi:[1,1]
    v_pk_mul_f32 v[20:21], v[20:21], v[64:65] op_sel:[0,1] op_sel_hi:[1,1]
    v_pk_mul_f32 v[22:23], v[22:23], v[64:65] op_sel:[0,1] op_sel_hi:[1,1]
    v_cvt_pk_bf16_f32 v8, v8, v9
    v_cvt_pk_bf16_f32 v10, v10, v11
    v_cvt_pk_bf16_f32 v12, v12, v13
    v_cvt_pk_bf16_f32 v14, v14, v15
    v_cvt_pk_bf16_f32 v16, v16, v17
    v_cvt_pk_bf16_f32 v18, v18, v19
    v_cvt_pk_bf16_f32 v20, v20, v21
    v_cvt_pk_bf16_f32 v22, v22, v23
    v_and_b32 v9, s17, v8
    v_lshlrev_b32 v8, 16, v8
    v_and_b32 v11, s17, v10
    v_lshlrev_b32 v10, 16, v10
    v_and_b32 v13, s17, v12
    v_lshlrev_b32 v12, 16, v12
    v_and_b32 v15, s17, v14
    v_lshlrev_b32 v14, 16, v14
    v_and_b32 v17, s17, v16
    v_lshlrev_b32 v16, 16, v16
    v_and_b32 v19, s17, v18
    v_lshlrev_b32 v18, 16, v18
    v_and_b32 v21, s17, v20
    v_lshlrev_b32 v20, 16, v20
    v_and_b32 v23, s17, v22
    v_lshlrev_b32 v22, 16, v22
    v_add_f32 v8, v8, v104
    v_add_f32 v9, v9, v106
    v_add_f32 v10, v10, v108
    v_add_f32 v11, v11, v110
    v_add_f32 v12, v12, v112
    v_add_f32 v13, v13, v114
    v_add_f32 v14, v14, v116
    v_add_f32 v15, v15, v118
    v_add_f32 v16, v16, v105
    v_add_f32 v17, v17, v107
    v_add_f32 v18, v18, v109
    v_add_f32 v19, v19, v111
    v_add_f32 v20, v20, v113
    v_add_f32 v21, v21, v115
    v_add_f32 v22, v22, v117
    v_add_f32 v23, v23, v119
    v_cvt_pk_bf16_f32 v24, v8, v9
    v_cvt_pk_bf16_f32 v25, v10, v11
    v_cvt_pk_bf16_f32 v26, v12, v13
    v_cvt_pk_bf16_f32 v27, v14, v15
    v_cvt_pk_bf16_f32 v28, v16, v17
    v_cvt_pk_bf16_f32 v29, v18, v19
    v_cvt_pk_bf16_f32 v30, v20, v21
    v_cvt_pk_bf16_f32 v31, v22, v23
    s_add_u32 s16, s3, 4352
    buffer_store_dwordx4 v[24:27], v5, s[28:31], s3 offen sc0 sc1
    buffer_store_dwordx4 v[28:31], v5, s[28:31], s16 offen sc0 sc1

    s_endpgm
K2_W2:
    v_lshrrev_b32 v3, 2, v1
    v_and_b32 v4, 3, v1
    v_lshlrev_b32 v5, 4, v1
    v_lshl_add_u32 v5, v2, 13, v5
    v_lshrrev_b32 v6, 4, v1
    v_and_b32 v7, 1, v6
    v_lshrrev_b32 v6, 1, v6
    v_bfe_u32 v8, v1, 2, 2
    v_lshlrev_b32 v9, 3, v4
    v_lshl_add_u32 v9, v7, 5, v9
    v_lshl_add_u32 v9, v8, 6, v9
    v_lshl_add_u32 v9, v2, 13, v9

    s_load_dwordx2 s[4:5], s[0:1], 96
    s_load_dwordx2 s[8:9], s[0:1], 144
    s_waitcnt lgkmcnt(0)
    s_and_b32 s5, s5, 0xffff
    s_mov_b32 s6, 0x1c0000
    s_mov_b32 s7, 0x00020000
    s_add_u32 s8, s8, 0xa00000
    s_addc_u32 s9, s9, 0
    s_and_b32 s9, s9, 0xffff
    s_mov_b32 s10, 0x1c4000
    s_mov_b32 s11, 0x00020000
    s_sub_u32 s3, s2, 368
    s_and_b32 s18, s3, 15
    s_lshr_b32 s19, s3, 4
    v_lshl_add_u32 v9, v6, 8, v9
    v_mul_u32_u24 v10, 112, v2
    v_add_u32 v10, v10, v3
    v_lshlrev_b32 v10, 10, v10
    v_lshl_add_u32 v10, v4, 4, v10
    s_mul_i32 s16, s19, 458752
    s_lshl_b32 s20, s18, 6
    s_add_u32 s16, s16, s20

    buffer_load_dwordx4 v[16:19], v10, s[4:7], s16 offen
    s_add_u32 s16, s16, 16384
    buffer_load_dwordx4 v[20:23], v10, s[4:7], s16 offen
    s_add_u32 s16, s16, 16384
    buffer_load_dwordx4 v[24:27], v10, s[4:7], s16 offen
    s_add_u32 s16, s16, 16384
    buffer_load_dwordx4 v[28:31], v10, s[4:7], s16 offen
    s_add_u32 s16, s16, 16384
    buffer_load_dwordx4 v[32:35], v10, s[4:7], s16 offen
    s_add_u32 s16, s16, 16384
    buffer_load_dwordx4 v[36:39], v10, s[4:7], s16 offen
    s_add_u32 s16, s16, 16384
    buffer_load_dwordx4 v[40:43], v10, s[4:7], s16 offen
    s_waitcnt vmcnt(6)
    ds_write_b128 v5, v[16:19] offset:0
    s_waitcnt vmcnt(5)
    ds_write_b128 v5, v[20:23] offset:1024
    s_waitcnt vmcnt(4)
    ds_write_b128 v5, v[24:27] offset:2048
    s_waitcnt vmcnt(3)
    ds_write_b128 v5, v[28:31] offset:3072
    s_waitcnt vmcnt(2)
    ds_write_b128 v5, v[32:35] offset:4096
    s_waitcnt vmcnt(1)
    ds_write_b128 v5, v[36:39] offset:5120
    s_waitcnt vmcnt(0)
    ds_write_b128 v5, v[40:43] offset:6144
    v_mul_u32_u24 v10, 7168, v2
    v_lshl_add_u32 v10, v1, 4, v10
    s_mul_i32 s16, s18, 114688
    s_mul_i32 s20, s19, 28672
    s_add_u32 s16, s16, s20
    s_waitcnt lgkmcnt(0)

    ds_read_b64_tr_b16 v[16:17], v9 offset:0
    ds_read_b64_tr_b16 v[18:19], v9 offset:512
    ds_read_b64_tr_b16 v[20:21], v9 offset:1024
    ds_read_b64_tr_b16 v[22:23], v9 offset:1536
    ds_read_b64_tr_b16 v[24:25], v9 offset:2048
    ds_read_b64_tr_b16 v[26:27], v9 offset:2560
    ds_read_b64_tr_b16 v[28:29], v9 offset:3072
    ds_read_b64_tr_b16 v[30:31], v9 offset:3584
    ds_read_b64_tr_b16 v[32:33], v9 offset:4096
    ds_read_b64_tr_b16 v[34:35], v9 offset:4608
    ds_read_b64_tr_b16 v[36:37], v9 offset:5120
    ds_read_b64_tr_b16 v[38:39], v9 offset:5632
    ds_read_b64_tr_b16 v[40:41], v9 offset:6144
    ds_read_b64_tr_b16 v[42:43], v9 offset:6656
    s_waitcnt lgkmcnt(12)
    buffer_store_dwordx4 v[16:19], v10, s[8:11], s16 offen offset:0 sc0 sc1
    s_waitcnt lgkmcnt(10)
    buffer_store_dwordx4 v[20:23], v10, s[8:11], s16 offen offset:1024 sc0 sc1
    s_waitcnt lgkmcnt(8)
    buffer_store_dwordx4 v[24:27], v10, s[8:11], s16 offen offset:2048 sc0 sc1
    s_waitcnt lgkmcnt(6)
    buffer_store_dwordx4 v[28:31], v10, s[8:11], s16 offen offset:3072 sc0 sc1
    s_add_u32 s16, s16, 4096
    s_waitcnt lgkmcnt(4)
    buffer_store_dwordx4 v[32:35], v10, s[8:11], s16 offen offset:0 sc0 sc1
    s_waitcnt lgkmcnt(2)
    buffer_store_dwordx4 v[36:39], v10, s[8:11], s16 offen offset:1024 sc0 sc1
    s_waitcnt lgkmcnt(0)
    buffer_store_dwordx4 v[40:43], v10, s[8:11], s16 offen offset:2048 sc0 sc1
    s_lshl_b32 s20, s3, 8
    s_add_u32 s20, s20, 1835008
    v_mov_b32 v11, 0
    v_lshlrev_b32 v12, 2, v1
    buffer_store_dword v11, v12, s[8:11], s20 offen sc0 sc1
    s_endpgm
K2_W:
    s_cmp_ge_u32 s2, 368
    s_cbranch_scc1 K2_W2
    v_lshrrev_b32 v3, 2, v1
    v_and_b32 v4, 3, v1
    v_lshlrev_b32 v5, 4, v1
    v_lshl_add_u32 v5, v2, 13, v5
    v_lshrrev_b32 v6, 4, v1
    v_and_b32 v7, 1, v6
    v_lshrrev_b32 v6, 1, v6
    v_bfe_u32 v8, v1, 2, 2
    v_lshlrev_b32 v9, 3, v4
    v_lshl_add_u32 v9, v7, 5, v9
    v_lshl_add_u32 v9, v8, 6, v9
    v_lshl_add_u32 v9, v2, 13, v9

    s_load_dwordx2 s[4:5], s[0:1], 80
    s_load_dwordx2 s[8:9], s[0:1], 144
    s_load_dwordx2 s[12:13], s[0:1], 144
    s_load_dwordx2 s[20:21], s[0:1], 144
    s_load_dwordx2 s[24:25], s[0:1], 88
    s_waitcnt lgkmcnt(0)
    s_and_b32 s5, s5, 0xffff
    s_mov_b32 s6, 0x1c0000
    s_mov_b32 s7, 0x00020000
    s_add_u32 s8, s8, 0x800000
    s_addc_u32 s9, s9, 0
    s_and_b32 s9, s9, 0xffff
    s_mov_b32 s10, 0x1c0000
    s_mov_b32 s11, 0x00020000
    s_add_u32 s12, s12, 0x210000
    s_addc_u32 s13, s13, 0
    s_and_b32 s13, s13, 0xffff
    s_mov_b32 s14, 0xc000
    s_mov_b32 s15, 0x00020000
    s_add_u32 s20, s20, 0xc00000
    s_addc_u32 s21, s21, 0
    s_and_b32 s21, s21, 0xffff
    s_mov_b32 s22, 0x7000
    s_mov_b32 s23, 0x00020000
    s_and_b32 s25, s25, 0xffff
    s_mov_b32 s26, 0xe00
    s_mov_b32 s27, 0x00020000
    s_sub_u32 s3, s2, 256
    s_and_b32 s18, s3, 1
    s_lshr_b32 s3, s3, 1
    s_lshl_b32 s19, s18, 8
    v_lshl_add_u32 v9, v6, 9, v9
    v_lshl_add_u32 v10, v2, 6, v3
    v_add_u32 v10, s19, v10
    v_mul_u32_u24 v11, 96, v10
    v_mul_u32_u24 v10, 3584, v10
    v_lshl_add_u32 v10, v4, 4, v10
    s_lshl_b32 s16, s3, 6
    v_and_b32 v12, 31, v1
    v_lshlrev_b32 v13, 1, v12
    buffer_load_ushort v14, v13, s[24:27], s16 offen

    s_mov_b32 s32, 0
    buffer_load_dwordx4 v[48:51], v11, s[12:15], s32 offen offset:48
    buffer_load_dwordx4 v[52:55], v11, s[12:15], s32 offen offset:64
    s_mov_b32 s32, 1536
    buffer_load_dwordx4 v[56:59], v11, s[12:15], s32 offen offset:48
    buffer_load_dwordx4 v[60:63], v11, s[12:15], s32 offen offset:64
    s_mov_b32 s32, 3072
    buffer_load_dwordx4 v[64:67], v11, s[12:15], s32 offen offset:48
    buffer_load_dwordx4 v[68:71], v11, s[12:15], s32 offen offset:64
    s_mov_b32 s32, 4608
    buffer_load_dwordx4 v[72:75], v11, s[12:15], s32 offen offset:48
    buffer_load_dwordx4 v[76:79], v11, s[12:15], s32 offen offset:64
    buffer_load_dwordx4 v[16:19], v10, s[4:7], s16 offen
    s_add_u32 s16, s16, 57344
    buffer_load_dwordx4 v[20:23], v10, s[4:7], s16 offen
    s_add_u32 s16, s16, 57344
    buffer_load_dwordx4 v[24:27], v10, s[4:7], s16 offen
    s_add_u32 s16, s16, 57344
    buffer_load_dwordx4 v[28:31], v10, s[4:7], s16 offen
    v_mov_b32 v112, 0
    v_mov_b32 v113, 0
    v_mov_b32 v114, 0
    v_mov_b32 v115, 0
    v_mov_b32 v116, 0
    v_mov_b32 v117, 0
    v_mov_b32 v118, 0
    v_mov_b32 v119, 0
    v_mov_b32 v120, 0
    v_mov_b32 v121, 0x3f803f80
    s_waitcnt vmcnt(4)
    v_add_f32 v48, v48, v49
    v_add_f32 v50, v50, v51
    v_add_f32 v48, v48, v50
    v_add_f32 v52, v52, v53
    v_add_f32 v54, v54, v55
    v_add_f32 v52, v52, v54
    v_add_f32 v56, v56, v57
    v_add_f32 v58, v58, v59
    v_add_f32 v56, v56, v58
    v_add_f32 v60, v60, v61
    v_add_f32 v62, v62, v63
    v_add_f32 v60, v60, v62
    v_add_f32 v64, v64, v65
    v_add_f32 v66, v66, v67
    v_add_f32 v64, v64, v66
    v_add_f32 v68, v68, v69
    v_add_f32 v70, v70, v71
    v_add_f32 v68, v68, v70
    v_add_f32 v72, v72, v73
    v_add_f32 v74, v74, v75
    v_add_f32 v72, v72, v74
    v_add_f32 v76, v76, v77
    v_add_f32 v78, v78, v79
    v_add_f32 v76, v76, v78
    v_cvt_pk_bf16_f32 v48, v48, v52
    v_cvt_pk_bf16_f32 v56, v56, v60
    v_cvt_pk_bf16_f32 v64, v64, v68
    v_cvt_pk_bf16_f32 v72, v72, v76
    v_and_b32 v52, s17, v48
    v_lshlrev_b32 v48, 16, v48
    v_and_b32 v60, s17, v56
    v_lshlrev_b32 v56, 16, v56
    v_and_b32 v68, s17, v64
    v_lshlrev_b32 v64, 16, v64
    v_and_b32 v76, s17, v72
    v_lshlrev_b32 v72, 16, v72
    v_add_f32 v52, 1.0, v52
    v_add_f32 v60, 1.0, v60
    v_add_f32 v68, 1.0, v68
    v_add_f32 v76, 1.0, v76
    v_cvt_pk_bf16_f32 v52, v52, v60
    v_cvt_pk_bf16_f32 v68, v68, v76
    v_and_b32 v60, s17, v52
    v_lshlrev_b32 v52, 16, v52
    v_and_b32 v76, s17, v68
    v_lshlrev_b32 v68, 16, v68
    s_waitcnt vmcnt(3)
    v_lshlrev_b32 v128, 16, v16
    v_and_b32 v129, s17, v16
    v_lshlrev_b32 v130, 16, v17
    v_and_b32 v131, s17, v17
    v_lshlrev_b32 v132, 16, v18
    v_and_b32 v133, s17, v18
    v_lshlrev_b32 v134, 16, v19
    v_and_b32 v135, s17, v19
    v_pk_fma_f32 v[112:113], v[128:129], v[48:49], v[112:113] op_sel_hi:[1,0,1]
    v_pk_fma_f32 v[114:115], v[130:131], v[48:49], v[114:115] op_sel_hi:[1,0,1]
    v_pk_fma_f32 v[116:117], v[132:133], v[48:49], v[116:117] op_sel_hi:[1,0,1]
    v_pk_fma_f32 v[118:119], v[134:135], v[48:49], v[118:119] op_sel_hi:[1,0,1]
    v_pk_mul_f32 v[128:129], v[128:129], v[52:53] op_sel_hi:[1,0]
    v_pk_mul_f32 v[130:131], v[130:131], v[52:53] op_sel_hi:[1,0]
    v_pk_mul_f32 v[132:133], v[132:133], v[52:53] op_sel_hi:[1,0]
    v_pk_mul_f32 v[134:135], v[134:135], v[52:53] op_sel_hi:[1,0]
    v_cvt_pk_bf16_f32 v16, v128, v129
    v_cvt_pk_bf16_f32 v17, v130, v131
    v_cvt_pk_bf16_f32 v18, v132, v133
    v_cvt_pk_bf16_f32 v19, v134, v135
    ds_write_b128 v5, v[16:19] offset:0
    s_waitcnt vmcnt(2)
    v_lshlrev_b32 v128, 16, v20
    v_and_b32 v129, s17, v20
    v_lshlrev_b32 v130, 16, v21
    v_and_b32 v131, s17, v21
    v_lshlrev_b32 v132, 16, v22
    v_and_b32 v133, s17, v22
    v_lshlrev_b32 v134, 16, v23
    v_and_b32 v135, s17, v23
    v_pk_fma_f32 v[112:113], v[128:129], v[56:57], v[112:113] op_sel_hi:[1,0,1]
    v_pk_fma_f32 v[114:115], v[130:131], v[56:57], v[114:115] op_sel_hi:[1,0,1]
    v_pk_fma_f32 v[116:117], v[132:133], v[56:57], v[116:117] op_sel_hi:[1,0,1]
    v_pk_fma_f32 v[118:119], v[134:135], v[56:57], v[118:119] op_sel_hi:[1,0,1]
    v_pk_mul_f32 v[128:129], v[128:129], v[60:61] op_sel_hi:[1,0]
    v_pk_mul_f32 v[130:131], v[130:131], v[60:61] op_sel_hi:[1,0]
    v_pk_mul_f32 v[132:133], v[132:133], v[60:61] op_sel_hi:[1,0]
    v_pk_mul_f32 v[134:135], v[134:135], v[60:61] op_sel_hi:[1,0]
    v_cvt_pk_bf16_f32 v20, v128, v129
    v_cvt_pk_bf16_f32 v21, v130, v131
    v_cvt_pk_bf16_f32 v22, v132, v133
    v_cvt_pk_bf16_f32 v23, v134, v135
    ds_write_b128 v5, v[20:23] offset:1024
    s_waitcnt vmcnt(1)
    v_lshlrev_b32 v128, 16, v24
    v_and_b32 v129, s17, v24
    v_lshlrev_b32 v130, 16, v25
    v_and_b32 v131, s17, v25
    v_lshlrev_b32 v132, 16, v26
    v_and_b32 v133, s17, v26
    v_lshlrev_b32 v134, 16, v27
    v_and_b32 v135, s17, v27
    v_pk_fma_f32 v[112:113], v[128:129], v[64:65], v[112:113] op_sel_hi:[1,0,1]
    v_pk_fma_f32 v[114:115], v[130:131], v[64:65], v[114:115] op_sel_hi:[1,0,1]
    v_pk_fma_f32 v[116:117], v[132:133], v[64:65], v[116:117] op_sel_hi:[1,0,1]
    v_pk_fma_f32 v[118:119], v[134:135], v[64:65], v[118:119] op_sel_hi:[1,0,1]
    v_pk_mul_f32 v[128:129], v[128:129], v[68:69] op_sel_hi:[1,0]
    v_pk_mul_f32 v[130:131], v[130:131], v[68:69] op_sel_hi:[1,0]
    v_pk_mul_f32 v[132:133], v[132:133], v[68:69] op_sel_hi:[1,0]
    v_pk_mul_f32 v[134:135], v[134:135], v[68:69] op_sel_hi:[1,0]
    v_cvt_pk_bf16_f32 v24, v128, v129
    v_cvt_pk_bf16_f32 v25, v130, v131
    v_cvt_pk_bf16_f32 v26, v132, v133
    v_cvt_pk_bf16_f32 v27, v134, v135
    ds_write_b128 v5, v[24:27] offset:2048
    s_waitcnt vmcnt(0)
    v_lshlrev_b32 v128, 16, v28
    v_and_b32 v129, s17, v28
    v_lshlrev_b32 v130, 16, v29
    v_and_b32 v131, s17, v29
    v_lshlrev_b32 v132, 16, v30
    v_and_b32 v133, s17, v30
    v_lshlrev_b32 v134, 16, v31
    v_and_b32 v135, s17, v31
    v_pk_fma_f32 v[112:113], v[128:129], v[72:73], v[112:113] op_sel_hi:[1,0,1]
    v_pk_fma_f32 v[114:115], v[130:131], v[72:73], v[114:115] op_sel_hi:[1,0,1]
    v_pk_fma_f32 v[116:117], v[132:133], v[72:73], v[116:117] op_sel_hi:[1,0,1]
    v_pk_fma_f32 v[118:119], v[134:135], v[72:73], v[118:119] op_sel_hi:[1,0,1]
    v_pk_mul_f32 v[128:129], v[128:129], v[76:77] op_sel_hi:[1,0]
    v_pk_mul_f32 v[130:131], v[130:131], v[76:77] op_sel_hi:[1,0]
    v_pk_mul_f32 v[132:133], v[132:133], v[76:77] op_sel_hi:[1,0]
    v_pk_mul_f32 v[134:135], v[134:135], v[76:77] op_sel_hi:[1,0]
    v_cvt_pk_bf16_f32 v28, v128, v129
    v_cvt_pk_bf16_f32 v29, v130, v131
    v_cvt_pk_bf16_f32 v30, v132, v133
    v_cvt_pk_bf16_f32 v31, v134, v135
    ds_write_b128 v5, v[28:31] offset:3072
    v_mul_u32_u24 v10, 48, v0
    ds_write_b128 v10, v[112:115] offset:32768
    ds_write_b128 v10, v[116:119] offset:32784
    s_waitcnt lgkmcnt(0)
    ds_read_b64_tr_b16 v[16:17], v9 offset:0
    ds_read_b64_tr_b16 v[18:19], v9 offset:256
    ds_read_b64_tr_b16 v[20:21], v9 offset:1024
    ds_read_b64_tr_b16 v[22:23], v9 offset:1280
    ds_read_b64_tr_b16 v[24:25], v9 offset:2048
    ds_read_b64_tr_b16 v[26:27], v9 offset:2304
    ds_read_b64_tr_b16 v[28:29], v9 offset:3072
    ds_read_b64_tr_b16 v[30:31], v9 offset:3328
    s_lshl_b32 s16, s3, 15
    s_lshl_b32 s19, s18, 14
    s_add_u32 s16, s16, s19
    v_lshlrev_b32 v10, 4, v1
    v_lshl_add_u32 v10, v2, 12, v10
    s_waitcnt lgkmcnt(6)
    buffer_store_dwordx4 v[16:19], v10, s[8:11], s16 offen offset:0 sc0 sc1
    v_dot2c_f32_bf16 v120, v16, v121
    v_dot2c_f32_bf16 v120, v17, v121
    v_dot2c_f32_bf16 v120, v18, v121
    v_dot2c_f32_bf16 v120, v19, v121
    s_waitcnt lgkmcnt(4)
    buffer_store_dwordx4 v[20:23], v10, s[8:11], s16 offen offset:1024 sc0 sc1
    v_dot2c_f32_bf16 v120, v20, v121
    v_dot2c_f32_bf16 v120, v21, v121
    v_dot2c_f32_bf16 v120, v22, v121
    v_dot2c_f32_bf16 v120, v23, v121
    s_waitcnt lgkmcnt(2)
    buffer_store_dwordx4 v[24:27], v10, s[8:11], s16 offen offset:2048 sc0 sc1
    v_dot2c_f32_bf16 v120, v24, v121
    v_dot2c_f32_bf16 v120, v25, v121
    v_dot2c_f32_bf16 v120, v26, v121
    v_dot2c_f32_bf16 v120, v27, v121
    s_waitcnt lgkmcnt(0)
    buffer_store_dwordx4 v[28:31], v10, s[8:11], s16 offen offset:3072 sc0 sc1
    v_dot2c_f32_bf16 v120, v28, v121
    v_dot2c_f32_bf16 v120, v29, v121
    v_dot2c_f32_bf16 v120, v30, v121
    v_dot2c_f32_bf16 v120, v31, v121
    v_lshlrev_b32 v10, 2, v0
    v_bfe_u32 v11, v1, 3, 2
    v_mul_u32_u24 v11, 48, v11
    ds_write_b32 v10, v120 offset:49152
    v_and_b32 v15, 7, v1
    v_lshl_add_u32 v11, v15, 2, v11
    v_lshrrev_b32 v15, 5, v0
    v_mul_u32_u24 v15, 1536, v15
    v_add_u32 v11, v11, v15
    s_barrier

    ds_read_b32 v48, v11 offset:32768
    ds_read_b32 v49, v11 offset:32960
    ds_read_b32 v50, v11 offset:33152
    ds_read_b32 v51, v11 offset:33344
    ds_read_b32 v52, v11 offset:33536
    ds_read_b32 v53, v11 offset:33728
    ds_read_b32 v54, v11 offset:33920
    ds_read_b32 v55, v11 offset:34112
    s_waitcnt lgkmcnt(0)
    v_add_f32 v48, v48, v49
    v_add_f32 v48, v48, v50
    v_add_f32 v48, v48, v51
    v_add_f32 v48, v48, v52
    v_add_f32 v48, v48, v53
    v_add_f32 v48, v48, v54
    v_add_f32 v48, v48, v55
    ds_write_b32 v10, v48 offset:50176
    v_lshrrev_b32 v11, 5, v1
    v_lshlrev_b32 v10, 10, v11
    v_lshl_add_u32 v10, v12, 2, v10
    s_waitcnt lgkmcnt(0)
    s_barrier

    ds_read_b32 v48, v10 offset:49152
    ds_read_b32 v49, v10 offset:49280
    ds_read_b32 v50, v10 offset:49408
    ds_read_b32 v51, v10 offset:49536
    ds_read_b32 v52, v10 offset:49664
    ds_read_b32 v53, v10 offset:49792
    ds_read_b32 v54, v10 offset:49920
    ds_read_b32 v55, v10 offset:50048
    v_lshlrev_b32 v13, 4, v12
    v_lshl_add_u32 v13, v11, 3, v13
    s_xor_b32 s19, s18, 1
    v_mul_u32_u24 v11, s19, v11
    v_cvt_f32_u32 v11, v11
    s_lshl_b32 s16, s3, 9
    s_lshl_b32 s19, s18, 2
    s_add_u32 s16, s16, s19
    v_lshlrev_b32 v14, 16, v14
    s_waitcnt lgkmcnt(0)

    v_add_f32 v48, v48, v49
    v_add_f32 v48, v48, v50
    v_add_f32 v48, v48, v51
    v_add_f32 v48, v48, v52
    v_add_f32 v48, v48, v53
    v_add_f32 v48, v48, v54
    v_add_f32 v48, v48, v55
    v_fmac_f32 v48, v11, v14
    v_cmp_gt_u32 vcc, 64, v0
    s_and_saveexec_b64 s[34:35], vcc
    s_cbranch_execz K2_END
    buffer_store_dword v48, v13, s[20:23], s16 offen sc0 sc1
K2_END:
    s_endpgm

.globl k3_kernel
.p2align 8
.type k3_kernel,@function
k3_kernel:
    s_cmp_ge_u32 s2, 256
    s_cbranch_scc1 K3_END
    s_load_dwordx2 s[4:5], s[0:1], 144
    s_load_dwordx2 s[8:9], s[0:1], 144
    s_load_dwordx2 s[12:13], s[0:1], 144
    s_load_dwordx2 s[20:21], s[0:1], 144
    s_load_dwordx2 s[40:41], s[0:1], 144
    s_load_dwordx2 s[44:45], s[0:1], 144
    s_load_dwordx2 s[48:49], s[0:1], 104
    s_load_dwordx2 s[52:53], s[0:1], 128
    s_and_b32 s3, s2, 7
    s_lshl_b32 s3, s3, 2
    s_bfe_u32 s16, s2, 0x20003
    s_or_b32 s3, s3, s16
    s_lshr_b32 s16, s2, 5
    v_and_b32 v1, 63, v0
    v_lshrrev_b32 v2, 6, v0
    s_mov_b32 s17, 0xffff0000
    v_readfirstlane_b32 s18, v2

    s_bfe_u32 s3, s2, 0x20001
    s_lshl_b32 s3, s3, 3
    s_bfe_u32 s16, s2, 0x30003
    s_or_b32 s3, s3, s16
    s_and_b32 s16, s2, 1
    s_lshl_b32 s16, s16, 2
    s_lshr_b32 s19, s2, 6
    s_or_b32 s16, s16, s19
    s_waitcnt lgkmcnt(0)
    s_add_u32 s4, s4, 0x2000000
    s_addc_u32 s5, s5, 0
    s_and_b32 s5, s5, 0xffff
    s_mov_b32 s6, 0x220000
    s_mov_b32 s7, 0x00020000
    s_add_u32 s8, s8, 0x800000
    s_addc_u32 s9, s9, 0
    s_and_b32 s9, s9, 0xffff
    s_mov_b32 s10, 0x1c0000
    s_mov_b32 s11, 0x00020000
    s_add_u32 s12, s12, 0xc00000
    s_addc_u32 s13, s13, 0
    s_and_b32 s13, s13, 0xffff
    s_mov_b32 s14, 0x7000
    s_mov_b32 s15, 0x00020000
    s_add_u32 s20, s20, 0x1000000
    s_addc_u32 s21, s21, 0
    s_and_b32 s21, s21, 0xffff
    s_mov_b32 s22, 0x700000
    s_mov_b32 s23, 0x00020000
    s_add_u32 s40, s40, 0xa00000
    s_addc_u32 s41, s41, 0
    s_and_b32 s41, s41, 0xffff
    s_mov_b32 s42, 0x1c4000
    s_mov_b32 s43, 0x00020000
    s_add_u32 s44, s44, 0x210000
    s_addc_u32 s45, s45, 0
    s_and_b32 s45, s45, 0xffff
    s_mov_b32 s46, 0xc000
    s_mov_b32 s47, 0x00020000
    s_and_b32 s49, s49, 0xffff
    s_mov_b32 s50, 0x400
    s_mov_b32 s51, 0x00020000
    s_and_b32 s53, s53, 0xffff
    s_mov_b32 s54, 0x200000
    s_mov_b32 s55, 0x00020000
    v_lshrrev_b32 v3, 3, v1
    v_and_b32 v4, 7, v1
    v_lshlrev_b32 v5, 1, v3
    v_and_b32 v5, 4, v5
    v_xor_b32 v4, v4, v5
    v_lshlrev_b32 v4, 4, v4
    v_mul_u32_u24 v3, 4352, v3
    v_add_u32 v4, v3, v4
    s_lshl_b32 s19, s3, 7
    s_mul_i32 s24, s18, 34816
    s_add_u32 s19, s19, s24
    s_lshl_b32 s25, s18, 10
    s_lshl_b32 s29, s16, 1
    s_add_u32 s29, s29, s3
    s_and_b32 s29, s29, 0
    v_lshlrev_b32 v5, 4, v1
    s_mul_i32 s26, s16, 7
    s_add_u32 s26, s26, s18
    s_lshl_b32 s27, s26, 15
    v_lshrrev_b32 v6, 4, v1
    v_and_b32 v7, 1, v6
    v_lshrrev_b32 v6, 1, v6
    v_bfe_u32 v8, v1, 2, 2
    v_and_b32 v9, 3, v1
    v_lshlrev_b32 v9, 3, v9
    v_lshl_add_u32 v9, v7, 5, v9
    v_lshl_add_u32 v9, v8, 7, v9
    v_lshl_add_u32 v9, v6, 10, v9
    v_lshrrev_b32 v8, 1, v8
    v_lshl_add_u32 v10, v8, 6, v9
    v_xor_b32 v11, 64, v10
    s_cmp_eq_u32 s18, 7
    s_cbranch_scc1 K3_ST

    v_and_b32 v12, 31, v1
    v_lshlrev_b32 v13, 4, v12
    s_lshl_b32 s28, s26, 9
    buffer_load_dwordx4 v[16:19], v13, s[12:15], s28 offen
    s_add_u32 m0, s25, 0
    s_mul_i32 s28, s29, 278528
    s_add_u32 s28, s28, s19
    buffer_load_dwordx4 v4, s[4:7], s28 offen lds
    s_lshl_b32 s28, s29, 12
    s_add_u32 s28, s28, s27
    buffer_load_dwordx4 v[64:67], v5, s[8:11], s28 offen offset:0
    buffer_load_dwordx4 v[68:71], v5, s[8:11], s28 offen offset:1024
    buffer_load_dwordx4 v[72:75], v5, s[8:11], s28 offen offset:2048
    buffer_load_dwordx4 v[76:79], v5, s[8:11], s28 offen offset:3072
    s_add_u32 s29, s29, 1
    s_and_b32 s29, s29, 7
    s_add_u32 m0, s25, 8192
    s_mul_i32 s28, s29, 278528
    s_add_u32 s28, s28, s19
    buffer_load_dwordx4 v4, s[4:7], s28 offen lds
    s_lshl_b32 s28, s29, 12
    s_add_u32 s28, s28, s27
    buffer_load_dwordx4 v[80:83], v5, s[8:11], s28 offen offset:0
    buffer_load_dwordx4 v[84:87], v5, s[8:11], s28 offen offset:1024
    buffer_load_dwordx4 v[88:91], v5, s[8:11], s28 offen offset:2048
    buffer_load_dwordx4 v[92:95], v5, s[8:11], s28 offen offset:3072
    s_add_u32 s29, s29, 1
    s_and_b32 s29, s29, 7
    s_add_u32 m0, s25, 16384
    s_mul_i32 s28, s29, 278528
    s_add_u32 s28, s28, s19
    buffer_load_dwordx4 v4, s[4:7], s28 offen lds
    s_lshl_b32 s28, s29, 12
    s_add_u32 s28, s28, s27
    buffer_load_dwordx4 v[96:99], v5, s[8:11], s28 offen offset:0
    buffer_load_dwordx4 v[100:103], v5, s[8:11], s28 offen offset:1024
    buffer_load_dwordx4 v[104:107], v5, s[8:11], s28 offen offset:2048
    buffer_load_dwordx4 v[108:111], v5, s[8:11], s28 offen offset:3072
    s_add_u32 s29, s29, 1
    s_and_b32 s29, s29, 7
    s_waitcnt vmcnt(14)
    s_barrier
    ds_read_b64_tr_b16 v[24:25], v10 offset:0
    ds_read_b64_tr_b16 v[26:27], v10 offset:512
    ds_read_b64_tr_b16 v[28:29], v11 offset:0
    ds_read_b64_tr_b16 v[30:31], v11 offset:512
    ds_read_b64_tr_b16 v[32:33], v10 offset:2048
    ds_read_b64_tr_b16 v[34:35], v10 offset:2560
    ds_read_b64_tr_b16 v[36:37], v11 offset:2048
    ds_read_b64_tr_b16 v[38:39], v11 offset:2560
    ds_read_b64_tr_b16 v[40:41], v10 offset:4096
    ds_read_b64_tr_b16 v[42:43], v10 offset:4608
    ds_read_b64_tr_b16 v[44:45], v11 offset:4096
    ds_read_b64_tr_b16 v[46:47], v11 offset:4608
    ds_read_b64_tr_b16 v[48:49], v10 offset:6144
    ds_read_b64_tr_b16 v[50:51], v10 offset:6656
    ds_read_b64_tr_b16 v[52:53], v11 offset:6144
    ds_read_b64_tr_b16 v[54:55], v11 offset:6656
    s_waitcnt vmcnt(10)
    s_waitcnt lgkmcnt(12)
    v_mfma_f32_32x32x16_bf16 v[192:207], v[64:67], v[24:27], 0
    v_mfma_f32_32x32x16_bf16 v[208:223], v[64:67], v[28:31], 0
    s_waitcnt lgkmcnt(8)
    v_mfma_f32_32x32x16_bf16 v[192:207], v[68:71], v[32:35], v[192:207]
    v_mfma_f32_32x32x16_bf16 v[208:223], v[68:71], v[36:39], v[208:223]
    s_waitcnt lgkmcnt(4)
    v_mfma_f32_32x32x16_bf16 v[192:207], v[72:75], v[40:43], v[192:207]
    v_mfma_f32_32x32x16_bf16 v[208:223], v[72:75], v[44:47], v[208:223]
    s_waitcnt lgkmcnt(0)
    v_mfma_f32_32x32x16_bf16 v[192:207], v[76:79], v[48:51], v[192:207]
    v_mfma_f32_32x32x16_bf16 v[208:223], v[76:79], v[52:55], v[208:223]
    s_add_u32 m0, s25, 24576
    s_mul_i32 s28, s29, 278528
    s_add_u32 s28, s28, s19
    buffer_load_dwordx4 v4, s[4:7], s28 offen lds
    s_lshl_b32 s28, s29, 12
    s_add_u32 s28, s28, s27
    buffer_load_dwordx4 v[112:115], v5, s[8:11], s28 offen offset:0
    buffer_load_dwordx4 v[116:119], v5, s[8:11], s28 offen offset:1024
    buffer_load_dwordx4 v[120:123], v5, s[8:11], s28 offen offset:2048
    buffer_load_dwordx4 v[124:127], v5, s[8:11], s28 offen offset:3072
    s_add_u32 s29, s29, 1
    s_and_b32 s29, s29, 7
    s_waitcnt vmcnt(14)
    s_barrier
    ds_read_b64_tr_b16 v[24:25], v10 offset:8192
    ds_read_b64_tr_b16 v[26:27], v10 offset:8704
    ds_read_b64_tr_b16 v[28:29], v11 offset:8192
    ds_read_b64_tr_b16 v[30:31], v11 offset:8704
    ds_read_b64_tr_b16 v[32:33], v10 offset:10240
    ds_read_b64_tr_b16 v[34:35], v10 offset:10752
    ds_read_b64_tr_b16 v[36:37], v11 offset:10240
    ds_read_b64_tr_b16 v[38:39], v11 offset:10752
    ds_read_b64_tr_b16 v[40:41], v10 offset:12288
    ds_read_b64_tr_b16 v[42:43], v10 offset:12800
    ds_read_b64_tr_b16 v[44:45], v11 offset:12288
    ds_read_b64_tr_b16 v[46:47], v11 offset:12800
    ds_read_b64_tr_b16 v[48:49], v10 offset:14336
    ds_read_b64_tr_b16 v[50:51], v10 offset:14848
    ds_read_b64_tr_b16 v[52:53], v11 offset:14336
    ds_read_b64_tr_b16 v[54:55], v11 offset:14848
    s_waitcnt vmcnt(10)
    s_waitcnt lgkmcnt(12)
    v_mfma_f32_32x32x16_bf16 v[192:207], v[80:83], v[24:27], v[192:207]
    v_mfma_f32_32x32x16_bf16 v[208:223], v[80:83], v[28:31], v[208:223]
    s_waitcnt lgkmcnt(8)
    v_mfma_f32_32x32x16_bf16 v[192:207], v[84:87], v[32:35], v[192:207]
    v_mfma_f32_32x32x16_bf16 v[208:223], v[84:87], v[36:39], v[208:223]
    s_waitcnt lgkmcnt(4)
    v_mfma_f32_32x32x16_bf16 v[192:207], v[88:91], v[40:43], v[192:207]
    v_mfma_f32_32x32x16_bf16 v[208:223], v[88:91], v[44:47], v[208:223]
    s_waitcnt lgkmcnt(0)
    v_mfma_f32_32x32x16_bf16 v[192:207], v[92:95], v[48:51], v[192:207]
    v_mfma_f32_32x32x16_bf16 v[208:223], v[92:95], v[52:55], v[208:223]
    s_add_u32 m0, s25, 32768
    s_mul_i32 s28, s29, 278528
    s_add_u32 s28, s28, s19
    buffer_load_dwordx4 v4, s[4:7], s28 offen lds
    s_lshl_b32 s28, s29, 12
    s_add_u32 s28, s28, s27
    buffer_load_dwordx4 v[64:67], v5, s[8:11], s28 offen offset:0
    buffer_load_dwordx4 v[68:71], v5, s[8:11], s28 offen offset:1024
    buffer_load_dwordx4 v[72:75], v5, s[8:11], s28 offen offset:2048
    buffer_load_dwordx4 v[76:79], v5, s[8:11], s28 offen offset:3072
    s_add_u32 s29, s29, 1
    s_and_b32 s29, s29, 7
    s_waitcnt vmcnt(14)
    s_barrier
    ds_read_b64_tr_b16 v[24:25], v10 offset:16384
    ds_read_b64_tr_b16 v[26:27], v10 offset:16896
    ds_read_b64_tr_b16 v[28:29], v11 offset:16384
    ds_read_b64_tr_b16 v[30:31], v11 offset:16896
    ds_read_b64_tr_b16 v[32:33], v10 offset:18432
    ds_read_b64_tr_b16 v[34:35], v10 offset:18944
    ds_read_b64_tr_b16 v[36:37], v11 offset:18432
    ds_read_b64_tr_b16 v[38:39], v11 offset:18944
    ds_read_b64_tr_b16 v[40:41], v10 offset:20480
    ds_read_b64_tr_b16 v[42:43], v10 offset:20992
    ds_read_b64_tr_b16 v[44:45], v11 offset:20480
    ds_read_b64_tr_b16 v[46:47], v11 offset:20992
    ds_read_b64_tr_b16 v[48:49], v10 offset:22528
    ds_read_b64_tr_b16 v[50:51], v10 offset:23040
    ds_read_b64_tr_b16 v[52:53], v11 offset:22528
    ds_read_b64_tr_b16 v[54:55], v11 offset:23040
    s_waitcnt vmcnt(10)
    s_waitcnt lgkmcnt(12)
    v_mfma_f32_32x32x16_bf16 v[192:207], v[96:99], v[24:27], v[192:207]
    v_mfma_f32_32x32x16_bf16 v[208:223], v[96:99], v[28:31], v[208:223]
    s_waitcnt lgkmcnt(8)
    v_mfma_f32_32x32x16_bf16 v[192:207], v[100:103], v[32:35], v[192:207]
    v_mfma_f32_32x32x16_bf16 v[208:223], v[100:103], v[36:39], v[208:223]
    s_waitcnt lgkmcnt(4)
    v_mfma_f32_32x32x16_bf16 v[192:207], v[104:107], v[40:43], v[192:207]
    v_mfma_f32_32x32x16_bf16 v[208:223], v[104:107], v[44:47], v[208:223]
    s_waitcnt lgkmcnt(0)
    v_mfma_f32_32x32x16_bf16 v[192:207], v[108:111], v[48:51], v[192:207]
    v_mfma_f32_32x32x16_bf16 v[208:223], v[108:111], v[52:55], v[208:223]
    s_add_u32 m0, s25, 40960
    s_mul_i32 s28, s29, 278528
    s_add_u32 s28, s28, s19
    buffer_load_dwordx4 v4, s[4:7], s28 offen lds
    s_lshl_b32 s28, s29, 12
    s_add_u32 s28, s28, s27
    buffer_load_dwordx4 v[80:83], v5, s[8:11], s28 offen offset:0
    buffer_load_dwordx4 v[84:87], v5, s[8:11], s28 offen offset:1024
    buffer_load_dwordx4 v[88:91], v5, s[8:11], s28 offen offset:2048
    buffer_load_dwordx4 v[92:95], v5, s[8:11], s28 offen offset:3072
    s_add_u32 s29, s29, 1
    s_and_b32 s29, s29, 7
    s_waitcnt vmcnt(14)
    s_barrier
    ds_read_b64_tr_b16 v[24:25], v10 offset:24576
    ds_read_b64_tr_b16 v[26:27], v10 offset:25088
    ds_read_b64_tr_b16 v[28:29], v11 offset:24576
    ds_read_b64_tr_b16 v[30:31], v11 offset:25088
    ds_read_b64_tr_b16 v[32:33], v10 offset:26624
    ds_read_b64_tr_b16 v[34:35], v10 offset:27136
    ds_read_b64_tr_b16 v[36:37], v11 offset:26624
    ds_read_b64_tr_b16 v[38:39], v11 offset:27136
    ds_read_b64_tr_b16 v[40:41], v10 offset:28672
    ds_read_b64_tr_b16 v[42:43], v10 offset:29184
    ds_read_b64_tr_b16 v[44:45], v11 offset:28672
    ds_read_b64_tr_b16 v[46:47], v11 offset:29184
    ds_read_b64_tr_b16 v[48:49], v10 offset:30720
    ds_read_b64_tr_b16 v[50:51], v10 offset:31232
    ds_read_b64_tr_b16 v[52:53], v11 offset:30720
    ds_read_b64_tr_b16 v[54:55], v11 offset:31232
    s_waitcnt vmcnt(10)
    s_waitcnt lgkmcnt(12)
    v_mfma_f32_32x32x16_bf16 v[192:207], v[112:115], v[24:27], v[192:207]
    v_mfma_f32_32x32x16_bf16 v[208:223], v[112:115], v[28:31], v[208:223]
    s_waitcnt lgkmcnt(8)
    v_mfma_f32_32x32x16_bf16 v[192:207], v[116:119], v[32:35], v[192:207]
    v_mfma_f32_32x32x16_bf16 v[208:223], v[116:119], v[36:39], v[208:223]
    s_waitcnt lgkmcnt(4)
    v_mfma_f32_32x32x16_bf16 v[192:207], v[120:123], v[40:43], v[192:207]
    v_mfma_f32_32x32x16_bf16 v[208:223], v[120:123], v[44:47], v[208:223]
    s_waitcnt lgkmcnt(0)
    v_mfma_f32_32x32x16_bf16 v[192:207], v[124:127], v[48:51], v[192:207]
    v_mfma_f32_32x32x16_bf16 v[208:223], v[124:127], v[52:55], v[208:223]
    s_add_u32 m0, s25, 49152
    s_mul_i32 s28, s29, 278528
    s_add_u32 s28, s28, s19
    buffer_load_dwordx4 v4, s[4:7], s28 offen lds
    s_lshl_b32 s28, s29, 12
    s_add_u32 s28, s28, s27
    buffer_load_dwordx4 v[96:99], v5, s[8:11], s28 offen offset:0
    buffer_load_dwordx4 v[100:103], v5, s[8:11], s28 offen offset:1024
    buffer_load_dwordx4 v[104:107], v5, s[8:11], s28 offen offset:2048
    buffer_load_dwordx4 v[108:111], v5, s[8:11], s28 offen offset:3072
    s_add_u32 s29, s29, 1
    s_and_b32 s29, s29, 7
    s_waitcnt vmcnt(14)
    s_barrier
    ds_read_b64_tr_b16 v[24:25], v10 offset:32768
    ds_read_b64_tr_b16 v[26:27], v10 offset:33280
    ds_read_b64_tr_b16 v[28:29], v11 offset:32768
    ds_read_b64_tr_b16 v[30:31], v11 offset:33280
    ds_read_b64_tr_b16 v[32:33], v10 offset:34816
    ds_read_b64_tr_b16 v[34:35], v10 offset:35328
    ds_read_b64_tr_b16 v[36:37], v11 offset:34816
    ds_read_b64_tr_b16 v[38:39], v11 offset:35328
    ds_read_b64_tr_b16 v[40:41], v10 offset:36864
    ds_read_b64_tr_b16 v[42:43], v10 offset:37376
    ds_read_b64_tr_b16 v[44:45], v11 offset:36864
    ds_read_b64_tr_b16 v[46:47], v11 offset:37376
    ds_read_b64_tr_b16 v[48:49], v10 offset:38912
    ds_read_b64_tr_b16 v[50:51], v10 offset:39424
    ds_read_b64_tr_b16 v[52:53], v11 offset:38912
    ds_read_b64_tr_b16 v[54:55], v11 offset:39424
    s_waitcnt vmcnt(10)
    s_waitcnt lgkmcnt(12)
    v_mfma_f32_32x32x16_bf16 v[192:207], v[64:67], v[24:27], v[192:207]
    v_mfma_f32_32x32x16_bf16 v[208:223], v[64:67], v[28:31], v[208:223]
    s_waitcnt lgkmcnt(8)
    v_mfma_f32_32x32x16_bf16 v[192:207], v[68:71], v[32:35], v[192:207]
    v_mfma_f32_32x32x16_bf16 v[208:223], v[68:71], v[36:39], v[208:223]
    s_waitcnt lgkmcnt(4)
    v_mfma_f32_32x32x16_bf16 v[192:207], v[72:75], v[40:43], v[192:207]
    v_mfma_f32_32x32x16_bf16 v[208:223], v[72:75], v[44:47], v[208:223]
    s_waitcnt lgkmcnt(0)
    v_mfma_f32_32x32x16_bf16 v[192:207], v[76:79], v[48:51], v[192:207]
    v_mfma_f32_32x32x16_bf16 v[208:223], v[76:79], v[52:55], v[208:223]
    s_add_u32 m0, s25, 57344
    s_mul_i32 s28, s29, 278528
    s_add_u32 s28, s28, s19
    buffer_load_dwordx4 v4, s[4:7], s28 offen lds
    s_lshl_b32 s28, s29, 12
    s_add_u32 s28, s28, s27
    buffer_load_dwordx4 v[112:115], v5, s[8:11], s28 offen offset:0
    buffer_load_dwordx4 v[116:119], v5, s[8:11], s28 offen offset:1024
    buffer_load_dwordx4 v[120:123], v5, s[8:11], s28 offen offset:2048
    buffer_load_dwordx4 v[124:127], v5, s[8:11], s28 offen offset:3072
    s_add_u32 s29, s29, 1
    s_and_b32 s29, s29, 7
    s_waitcnt vmcnt(14)
    s_barrier
    ds_read_b64_tr_b16 v[24:25], v10 offset:40960
    ds_read_b64_tr_b16 v[26:27], v10 offset:41472
    ds_read_b64_tr_b16 v[28:29], v11 offset:40960
    ds_read_b64_tr_b16 v[30:31], v11 offset:41472
    ds_read_b64_tr_b16 v[32:33], v10 offset:43008
    ds_read_b64_tr_b16 v[34:35], v10 offset:43520
    ds_read_b64_tr_b16 v[36:37], v11 offset:43008
    ds_read_b64_tr_b16 v[38:39], v11 offset:43520
    ds_read_b64_tr_b16 v[40:41], v10 offset:45056
    ds_read_b64_tr_b16 v[42:43], v10 offset:45568
    ds_read_b64_tr_b16 v[44:45], v11 offset:45056
    ds_read_b64_tr_b16 v[46:47], v11 offset:45568
    ds_read_b64_tr_b16 v[48:49], v10 offset:47104
    ds_read_b64_tr_b16 v[50:51], v10 offset:47616
    ds_read_b64_tr_b16 v[52:53], v11 offset:47104
    ds_read_b64_tr_b16 v[54:55], v11 offset:47616
    s_waitcnt vmcnt(10)
    s_waitcnt lgkmcnt(12)
    v_mfma_f32_32x32x16_bf16 v[192:207], v[80:83], v[24:27], v[192:207]
    v_mfma_f32_32x32x16_bf16 v[208:223], v[80:83], v[28:31], v[208:223]
    s_waitcnt lgkmcnt(8)
    v_mfma_f32_32x32x16_bf16 v[192:207], v[84:87], v[32:35], v[192:207]
    v_mfma_f32_32x32x16_bf16 v[208:223], v[84:87], v[36:39], v[208:223]
    s_waitcnt lgkmcnt(4)
    v_mfma_f32_32x32x16_bf16 v[192:207], v[88:91], v[40:43], v[192:207]
    v_mfma_f32_32x32x16_bf16 v[208:223], v[88:91], v[44:47], v[208:223]
    s_waitcnt lgkmcnt(0)
    v_mfma_f32_32x32x16_bf16 v[192:207], v[92:95], v[48:51], v[192:207]
    v_mfma_f32_32x32x16_bf16 v[208:223], v[92:95], v[52:55], v[208:223]
    s_waitcnt vmcnt(9)
    s_barrier
    ds_read_b64_tr_b16 v[24:25], v10 offset:49152
    ds_read_b64_tr_b16 v[26:27], v10 offset:49664
    ds_read_b64_tr_b16 v[28:29], v11 offset:49152
    ds_read_b64_tr_b16 v[30:31], v11 offset:49664
    ds_read_b64_tr_b16 v[32:33], v10 offset:51200
    ds_read_b64_tr_b16 v[34:35], v10 offset:51712
    ds_read_b64_tr_b16 v[36:37], v11 offset:51200
    ds_read_b64_tr_b16 v[38:39], v11 offset:51712
    ds_read_b64_tr_b16 v[40:41], v10 offset:53248
    ds_read_b64_tr_b16 v[42:43], v10 offset:53760
    ds_read_b64_tr_b16 v[44:45], v11 offset:53248
    ds_read_b64_tr_b16 v[46:47], v11 offset:53760
    ds_read_b64_tr_b16 v[48:49], v10 offset:55296
    ds_read_b64_tr_b16 v[50:51], v10 offset:55808
    ds_read_b64_tr_b16 v[52:53], v11 offset:55296
    ds_read_b64_tr_b16 v[54:55], v11 offset:55808
    s_waitcnt vmcnt(5)
    s_waitcnt lgkmcnt(12)
    v_mfma_f32_32x32x16_bf16 v[192:207], v[96:99], v[24:27], v[192:207]
    v_mfma_f32_32x32x16_bf16 v[208:223], v[96:99], v[28:31], v[208:223]
    s_waitcnt lgkmcnt(8)
    v_mfma_f32_32x32x16_bf16 v[192:207], v[100:103], v[32:35], v[192:207]
    v_mfma_f32_32x32x16_bf16 v[208:223], v[100:103], v[36:39], v[208:223]
    s_waitcnt lgkmcnt(4)
    v_mfma_f32_32x32x16_bf16 v[192:207], v[104:107], v[40:43], v[192:207]
    v_mfma_f32_32x32x16_bf16 v[208:223], v[104:107], v[44:47], v[208:223]
    s_waitcnt lgkmcnt(0)
    v_mfma_f32_32x32x16_bf16 v[192:207], v[108:111], v[48:51], v[192:207]
    v_mfma_f32_32x32x16_bf16 v[208:223], v[108:111], v[52:55], v[208:223]
    s_waitcnt vmcnt(4)
    s_barrier
    ds_read_b64_tr_b16 v[24:25], v10 offset:57344
    ds_read_b64_tr_b16 v[26:27], v10 offset:57856
    ds_read_b64_tr_b16 v[28:29], v11 offset:57344
    ds_read_b64_tr_b16 v[30:31], v11 offset:57856
    ds_read_b64_tr_b16 v[32:33], v10 offset:59392
    ds_read_b64_tr_b16 v[34:35], v10 offset:59904
    ds_read_b64_tr_b16 v[36:37], v11 offset:59392
    ds_read_b64_tr_b16 v[38:39], v11 offset:59904
    ds_read_b64_tr_b16 v[40:41], v10 offset:61440
    ds_read_b64_tr_b16 v[42:43], v10 offset:61952
    ds_read_b64_tr_b16 v[44:45], v11 offset:61440
    ds_read_b64_tr_b16 v[46:47], v11 offset:61952
    ds_read_b64_tr_b16 v[48:49], v10 offset:63488
    ds_read_b64_tr_b16 v[50:51], v10 offset:64000
    ds_read_b64_tr_b16 v[52:53], v11 offset:63488
    ds_read_b64_tr_b16 v[54:55], v11 offset:64000
    s_waitcnt vmcnt(0)
    s_waitcnt lgkmcnt(12)
    v_mfma_f32_32x32x16_bf16 v[192:207], v[112:115], v[24:27], v[192:207]
    v_mfma_f32_32x32x16_bf16 v[208:223], v[112:115], v[28:31], v[208:223]
    s_waitcnt lgkmcnt(8)
    v_mfma_f32_32x32x16_bf16 v[192:207], v[116:119], v[32:35], v[192:207]
    v_mfma_f32_32x32x16_bf16 v[208:223], v[116:119], v[36:39], v[208:223]
    s_waitcnt lgkmcnt(4)
    v_mfma_f32_32x32x16_bf16 v[192:207], v[120:123], v[40:43], v[192:207]
    v_mfma_f32_32x32x16_bf16 v[208:223], v[120:123], v[44:47], v[208:223]
    s_waitcnt lgkmcnt(0)
    v_mfma_f32_32x32x16_bf16 v[192:207], v[124:127], v[48:51], v[192:207]
    v_mfma_f32_32x32x16_bf16 v[208:223], v[124:127], v[52:55], v[208:223]
    s_mul_i32 s27, s3, 229376
    s_lshl_b32 s28, s26, 11
    s_add_u32 s27, s27, s28

    s_lshl_b32 s30, s3, 9
    s_lshl_b32 s29, s16, 6
    s_add_u32 s30, s30, s29
    s_add_u32 s30, s30, 1835008
    s_cmp_ge_u32 s18, 4
    s_cbranch_scc1 K3_NOPRE

    s_and_b32 s3, s2, 7
    s_lshl_b32 s3, s3, 2
    s_bfe_u32 s16, s2, 0x20003
    s_or_b32 s3, s3, s16
    s_lshr_b32 s16, s2, 5
    v_and_b32 v1, 63, v0
    v_lshrrev_b32 v2, 6, v0
    s_mov_b32 s17, 0xffff0000
    v_readfirstlane_b32 s18, v2

    s_waitcnt lgkmcnt(0)
    v_mul_u32_u24 v3, 28672, v2
    v_lshl_add_u32 v3, v1, 4, v3
    s_lshr_b32 s36, s18, 1
    s_and_b32 s37, s18, 1
    s_lshl_b32 s32, s3, 1
    s_add_u32 s32, s32, s36
    s_xor_b32 s33, s32, 1
    s_lshl_b32 s34, s16, 1
    s_add_u32 s34, s34, s37
    s_xor_b32 s35, s34, 1
    s_lshl_b32 s38, s3, 1
    s_add_u32 s38, s38, s16
    s_and_b32 s38, s38, 0
    s_mul_i32 s38, s38, 7
    s_lshr_b32 s38, s38, 1
    s_lshl_b32 s38, s38, 10

    s_mul_i32 s32, s32, 114688
    v_add_u32 v28, s32, v3
    s_mul_i32 s33, s33, 114688
    v_add_u32 v29, s33, v3
    s_mul_i32 s34, s34, 114688
    v_add_u32 v30, s34, v3
    s_mul_i32 s35, s35, 114688
    v_add_u32 v31, s35, v3
    buffer_load_dwordx4 v[40:43], v30, s[40:43], s38 offen
    buffer_load_dwordx4 v[44:47], v31, s[40:43], s38 offen
    s_add_u32 s38, s38, 1024
    buffer_load_dwordx4 v[56:59], v30, s[40:43], s38 offen
    buffer_load_dwordx4 v[60:63], v31, s[40:43], s38 offen
    s_add_u32 s38, s38, 1024
    buffer_load_dwordx4 v[72:75], v30, s[40:43], s38 offen
    buffer_load_dwordx4 v[76:79], v31, s[40:43], s38 offen
    s_add_u32 s38, s38, 1024
    buffer_load_dwordx4 v[88:91], v30, s[40:43], s38 offen
    buffer_load_dwordx4 v[92:95], v31, s[40:43], s38 offen
    s_add_u32 s38, s38, 1024
    buffer_load_dwordx4 v[104:107], v30, s[40:43], s38 offen
    buffer_load_dwordx4 v[108:111], v31, s[40:43], s38 offen
    s_add_u32 s38, s38, 1024
    buffer_load_dwordx4 v[120:123], v30, s[40:43], s38 offen
    buffer_load_dwordx4 v[124:127], v31, s[40:43], s38 offen
    s_add_u32 s38, s38, 1024
    buffer_load_dwordx4 v[136:139], v30, s[40:43], s38 offen
    buffer_load_dwordx4 v[140:143], v31, s[40:43], s38 offen
    s_add_u32 s38, s38, 1024
    buffer_load_dwordx4 v[152:155], v30, s[40:43], s38 offen
    buffer_load_dwordx4 v[156:159], v31, s[40:43], s38 offen
    s_add_u32 s38, s38, 1024
    buffer_load_dwordx4 v[168:171], v30, s[40:43], s38 offen
    buffer_load_dwordx4 v[172:175], v31, s[40:43], s38 offen
    s_add_u32 s38, s38, 1024
    buffer_load_dwordx4 v[184:187], v30, s[40:43], s38 offen
    buffer_load_dwordx4 v[188:191], v31, s[40:43], s38 offen
    s_add_u32 s38, s38, 1024
K3_NOPRE:
    v_add_f32 v16, v16, v17
    v_add_f32 v17, v18, v19
    s_lshl_b32 s28, s18, 8
    s_add_u32 s28, s28, 0x10400
    v_lshl_add_u32 v13, v12, 2, s28
    ds_write2_b32 v13, v16, v17 offset1:32
    v_lshl_add_u32 v13, v6, 4, s28
    s_waitcnt lgkmcnt(0)

    ds_read_b128 v[224:227], v13 offset:0
    ds_read_b128 v[240:243], v13 offset:128
    ds_read_b128 v[228:231], v13 offset:32
    ds_read_b128 v[244:247], v13 offset:160
    ds_read_b128 v[232:235], v13 offset:64
    ds_read_b128 v[248:251], v13 offset:192
    ds_read_b128 v[236:239], v13 offset:96
    ds_read_b128 v[252:255], v13 offset:224
    v_and_b32 v12, 31, v1
    v_lshlrev_b32 v12, 3, v12
    v_add_u32 v12, 0x10000, v12
    s_barrier

    ds_read_b64 v[32:33], v12 offset:0
    ds_read_b64 v[34:35], v12 offset:256
    ds_read_b64 v[36:37], v12 offset:512
    ds_read_b64 v[38:39], v12 offset:768
    s_waitcnt lgkmcnt(0)
    v_add_f32 v32, v32, v34
    v_add_f32 v33, v33, v35
    v_mul_f32 v32, 0x3b000000, v32
    v_mul_f32 v33, 0x3b000000, v33
    v_fma_f32 v33, -v32, v32, v33
    v_max_f32 v33, 0, v33
    v_cvt_pk_bf16_f32 v32, v32, v33
    v_and_b32 v33, s17, v32
    v_lshlrev_b32 v32, 16, v32
    v_add_f32 v33, 0x3727c5ac, v33
    v_cvt_pk_bf16_f32 v33, v33, v33
    v_lshlrev_b32 v33, 16, v33
    v_sqrt_f32 v33, v33
    s_nop 0
    v_cvt_pk_bf16_f32 v33, v33, v33
    v_lshlrev_b32 v33, 16, v33
    v_rcp_f32 v33, v33

    v_add_f32 v36, v36, v38
    v_add_f32 v37, v37, v39
    v_mul_f32 v36, 0x3b000000, v36
    v_mul_f32 v37, 0x3b000000, v37
    v_fma_f32 v37, -v36, v36, v37
    v_max_f32 v37, 0, v37
    v_cvt_pk_bf16_f32 v36, v36, v37
    v_and_b32 v37, s17, v36
    v_lshlrev_b32 v36, 16, v36
    v_add_f32 v37, 0x3727c5ac, v37
    v_cvt_pk_bf16_f32 v37, v37, v37
    v_lshlrev_b32 v37, 16, v37
    v_sqrt_f32 v37, v37
    s_nop 0
    v_cvt_pk_bf16_f32 v37, v37, v37
    v_lshlrev_b32 v37, 16, v37
    v_rcp_f32 v37, v37

    v_pk_fma_f32 v[192:193], v[32:33], v[224:225], v[192:193] op_sel_hi:[0,1,1] neg_lo:[1,0,0] neg_hi:[1,0,0]
    v_pk_fma_f32 v[194:195], v[32:33], v[226:227], v[194:195] op_sel_hi:[0,1,1] neg_lo:[1,0,0] neg_hi:[1,0,0]
    v_pk_fma_f32 v[196:197], v[32:33], v[228:229], v[196:197] op_sel_hi:[0,1,1] neg_lo:[1,0,0] neg_hi:[1,0,0]
    v_pk_fma_f32 v[198:199], v[32:33], v[230:231], v[198:199] op_sel_hi:[0,1,1] neg_lo:[1,0,0] neg_hi:[1,0,0]
    v_pk_fma_f32 v[200:201], v[32:33], v[232:233], v[200:201] op_sel_hi:[0,1,1] neg_lo:[1,0,0] neg_hi:[1,0,0]
    v_pk_fma_f32 v[202:203], v[32:33], v[234:235], v[202:203] op_sel_hi:[0,1,1] neg_lo:[1,0,0] neg_hi:[1,0,0]
    v_pk_fma_f32 v[204:205], v[32:33], v[236:237], v[204:205] op_sel_hi:[0,1,1] neg_lo:[1,0,0] neg_hi:[1,0,0]
    v_pk_fma_f32 v[206:207], v[32:33], v[238:239], v[206:207] op_sel_hi:[0,1,1] neg_lo:[1,0,0] neg_hi:[1,0,0]
    v_pk_fma_f32 v[192:193], v[192:193], v[32:33], v[240:241] op_sel:[0,1,0] op_sel_hi:[1,1,1]
    v_pk_fma_f32 v[194:195], v[194:195], v[32:33], v[242:243] op_sel:[0,1,0] op_sel_hi:[1,1,1]
    v_pk_fma_f32 v[196:197], v[196:197], v[32:33], v[244:245] op_sel:[0,1,0] op_sel_hi:[1,1,1]
    v_pk_fma_f32 v[198:199], v[198:199], v[32:33], v[246:247] op_sel:[0,1,0] op_sel_hi:[1,1,1]
    v_pk_fma_f32 v[200:201], v[200:201], v[32:33], v[248:249] op_sel:[0,1,0] op_sel_hi:[1,1,1]
    v_pk_fma_f32 v[202:203], v[202:203], v[32:33], v[250:251] op_sel:[0,1,0] op_sel_hi:[1,1,1]
    v_pk_fma_f32 v[204:205], v[204:205], v[32:33], v[252:253] op_sel:[0,1,0] op_sel_hi:[1,1,1]
    v_pk_fma_f32 v[206:207], v[206:207], v[32:33], v[254:255] op_sel:[0,1,0] op_sel_hi:[1,1,1]
    v_max_f32 v192, 0, v192
    v_max_f32 v193, 0, v193
    v_max_f32 v194, 0, v194
    v_max_f32 v195, 0, v195
    v_max_f32 v196, 0, v196
    v_max_f32 v197, 0, v197
    v_max_f32 v198, 0, v198
    v_max_f32 v199, 0, v199
    v_max_f32 v200, 0, v200
    v_max_f32 v201, 0, v201
    v_max_f32 v202, 0, v202
    v_max_f32 v203, 0, v203
    v_max_f32 v204, 0, v204
    v_max_f32 v205, 0, v205
    v_max_f32 v206, 0, v206
    v_max_f32 v207, 0, v207
    v_pk_mul_f32 v[192:193], v[192:193], v[192:193]
    v_pk_mul_f32 v[194:195], v[194:195], v[194:195]
    v_pk_mul_f32 v[196:197], v[196:197], v[196:197]
    v_pk_mul_f32 v[198:199], v[198:199], v[198:199]
    v_pk_mul_f32 v[200:201], v[200:201], v[200:201]
    v_pk_mul_f32 v[202:203], v[202:203], v[202:203]
    v_pk_mul_f32 v[204:205], v[204:205], v[204:205]
    v_pk_mul_f32 v[206:207], v[206:207], v[206:207]
    v_cvt_pk_bf16_f32 v64, v192, v193
    v_cvt_pk_bf16_f32 v65, v194, v195
    v_cvt_pk_bf16_f32 v66, v196, v197
    v_cvt_pk_bf16_f32 v67, v198, v199
    v_cvt_pk_bf16_f32 v68, v200, v201
    v_cvt_pk_bf16_f32 v69, v202, v203
    v_cvt_pk_bf16_f32 v70, v204, v205
    v_cvt_pk_bf16_f32 v71, v206, v207
    buffer_store_dwordx4 v[64:67], v5, s[20:23], s27 offen offset:0 sc0 sc1
    buffer_store_dwordx4 v[68:71], v5, s[20:23], s27 offen offset:1024 sc0 sc1
    s_add_u32 s27, s27, 114688
    v_pk_fma_f32 v[208:209], v[36:37], v[224:225], v[208:209] op_sel_hi:[0,1,1] neg_lo:[1,0,0] neg_hi:[1,0,0]
    v_pk_fma_f32 v[210:211], v[36:37], v[226:227], v[210:211] op_sel_hi:[0,1,1] neg_lo:[1,0,0] neg_hi:[1,0,0]
    v_pk_fma_f32 v[212:213], v[36:37], v[228:229], v[212:213] op_sel_hi:[0,1,1] neg_lo:[1,0,0] neg_hi:[1,0,0]
    v_pk_fma_f32 v[214:215], v[36:37], v[230:231], v[214:215] op_sel_hi:[0,1,1] neg_lo:[1,0,0] neg_hi:[1,0,0]
    v_pk_fma_f32 v[216:217], v[36:37], v[232:233], v[216:217] op_sel_hi:[0,1,1] neg_lo:[1,0,0] neg_hi:[1,0,0]
    v_pk_fma_f32 v[218:219], v[36:37], v[234:235], v[218:219] op_sel_hi:[0,1,1] neg_lo:[1,0,0] neg_hi:[1,0,0]
    v_pk_fma_f32 v[220:221], v[36:37], v[236:237], v[220:221] op_sel_hi:[0,1,1] neg_lo:[1,0,0] neg_hi:[1,0,0]
    v_pk_fma_f32 v[222:223], v[36:37], v[238:239], v[222:223] op_sel_hi:[0,1,1] neg_lo:[1,0,0] neg_hi:[1,0,0]
    v_pk_fma_f32 v[208:209], v[208:209], v[36:37], v[240:241] op_sel:[0,1,0] op_sel_hi:[1,1,1]
    v_pk_fma_f32 v[210:211], v[210:211], v[36:37], v[242:243] op_sel:[0,1,0] op_sel_hi:[1,1,1]
    v_pk_fma_f32 v[212:213], v[212:213], v[36:37], v[244:245] op_sel:[0,1,0] op_sel_hi:[1,1,1]
    v_pk_fma_f32 v[214:215], v[214:215], v[36:37], v[246:247] op_sel:[0,1,0] op_sel_hi:[1,1,1]
    v_pk_fma_f32 v[216:217], v[216:217], v[36:37], v[248:249] op_sel:[0,1,0] op_sel_hi:[1,1,1]
    v_pk_fma_f32 v[218:219], v[218:219], v[36:37], v[250:251] op_sel:[0,1,0] op_sel_hi:[1,1,1]
    v_pk_fma_f32 v[220:221], v[220:221], v[36:37], v[252:253] op_sel:[0,1,0] op_sel_hi:[1,1,1]
    v_pk_fma_f32 v[222:223], v[222:223], v[36:37], v[254:255] op_sel:[0,1,0] op_sel_hi:[1,1,1]
    v_max_f32 v208, 0, v208
    v_max_f32 v209, 0, v209
    v_max_f32 v210, 0, v210
    v_max_f32 v211, 0, v211
    v_max_f32 v212, 0, v212
    v_max_f32 v213, 0, v213
    v_max_f32 v214, 0, v214
    v_max_f32 v215, 0, v215
    v_max_f32 v216, 0, v216
    v_max_f32 v217, 0, v217
    v_max_f32 v218, 0, v218
    v_max_f32 v219, 0, v219
    v_max_f32 v220, 0, v220
    v_max_f32 v221, 0, v221
    v_max_f32 v222, 0, v222
    v_max_f32 v223, 0, v223
    v_pk_mul_f32 v[208:209], v[208:209], v[208:209]
    v_pk_mul_f32 v[210:211], v[210:211], v[210:211]
    v_pk_mul_f32 v[212:213], v[212:213], v[212:213]
    v_pk_mul_f32 v[214:215], v[214:215], v[214:215]
    v_pk_mul_f32 v[216:217], v[216:217], v[216:217]
    v_pk_mul_f32 v[218:219], v[218:219], v[218:219]
    v_pk_mul_f32 v[220:221], v[220:221], v[220:221]
    v_pk_mul_f32 v[222:223], v[222:223], v[222:223]
    v_cvt_pk_bf16_f32 v80, v208, v209
    v_cvt_pk_bf16_f32 v81, v210, v211
    v_cvt_pk_bf16_f32 v82, v212, v213
    v_cvt_pk_bf16_f32 v83, v214, v215
    v_cvt_pk_bf16_f32 v84, v216, v217
    v_cvt_pk_bf16_f32 v85, v218, v219
    v_cvt_pk_bf16_f32 v86, v220, v221
    v_cvt_pk_bf16_f32 v87, v222, v223
    buffer_store_dwordx4 v[80:83], v5, s[20:23], s27 offen offset:0 sc0 sc1
    buffer_store_dwordx4 v[84:87], v5, s[20:23], s27 offen offset:1024 sc0 sc1
    v_mov_b32 v12, 1
    s_cmp_ge_u32 s18, 4
    s_cbranch_scc0 K3_F4
    s_waitcnt vmcnt(0)
    s_endpgm
K3_F4:

    s_waitcnt vmcnt(0)
    s_barrier
    s_cmp_lg_u32 s18, 0
    s_cbranch_scc1 K34_NF
    s_mov_b64 exec, 1
    buffer_store_dword v12, off, s[40:43], s30 sc0 sc1
    s_mov_b64 exec, -1
K34_NF:
    s_lshl_b32 s28, s3, 9
    s_add_u32 s28, s28, 1835008
    s_mov_b32 s38, 0
    s_mov_b32 s39, 0
    s_cmp_lg_u32 s18, 0
    s_cbranch_scc1 K34_GO
    v_lshlrev_b32 v5, 6, v1
    s_mov_b64 exec, 0xff
K34_SPIN:
    buffer_load_dword v4, v5, s[40:43], s28 offen sc0 sc1
    s_add_u32 s39, s39, 1
    s_waitcnt vmcnt(0)
    v_cmp_eq_u32 vcc, 1, v4
    s_cmp_ge_u32 s39, 20000
    s_cbranch_scc1 K34_OUT
    s_cmp_lg_u32 vcc_lo, 0xff
    s_cbranch_scc1 K34_SPIN
K34_OUT:
    s_mov_b64 exec, -1
K34_GO:
    s_waitcnt vmcnt(0)
    s_barrier

    buffer_load_dwordx4 v[32:35], v28, s[20:23], s38 offen
    buffer_load_dwordx4 v[36:39], v29, s[20:23], s38 offen
    s_add_u32 s38, s38, 1024
    buffer_load_dwordx4 v[48:51], v28, s[20:23], s38 offen
    buffer_load_dwordx4 v[52:55], v29, s[20:23], s38 offen
    s_add_u32 s38, s38, 1024
    buffer_load_dwordx4 v[64:67], v28, s[20:23], s38 offen
    buffer_load_dwordx4 v[68:71], v29, s[20:23], s38 offen
    s_add_u32 s38, s38, 1024
    buffer_load_dwordx4 v[80:83], v28, s[20:23], s38 offen
    buffer_load_dwordx4 v[84:87], v29, s[20:23], s38 offen
    s_add_u32 s38, s38, 1024
    buffer_load_dwordx4 v[96:99], v28, s[20:23], s38 offen
    buffer_load_dwordx4 v[100:103], v29, s[20:23], s38 offen
    s_add_u32 s38, s38, 1024
    buffer_load_dwordx4 v[112:115], v28, s[20:23], s38 offen
    buffer_load_dwordx4 v[116:119], v29, s[20:23], s38 offen
    s_add_u32 s38, s38, 1024
    buffer_load_dwordx4 v[128:131], v28, s[20:23], s38 offen
    buffer_load_dwordx4 v[132:135], v29, s[20:23], s38 offen
    s_add_u32 s38, s38, 1024
    buffer_load_dwordx4 v[144:147], v28, s[20:23], s38 offen
    buffer_load_dwordx4 v[148:151], v29, s[20:23], s38 offen
    s_add_u32 s38, s38, 1024
    buffer_load_dwordx4 v[160:163], v28, s[20:23], s38 offen
    buffer_load_dwordx4 v[164:167], v29, s[20:23], s38 offen
    s_add_u32 s38, s38, 1024
    buffer_load_dwordx4 v[176:179], v28, s[20:23], s38 offen
    buffer_load_dwordx4 v[180:183], v29, s[20:23], s38 offen
    s_add_u32 s38, s38, 1024
    v_and_b32 v4, 31, v1
    v_lshrrev_b32 v5, 5, v1
    v_and_b32 v6, 1, v2
    v_lshl_add_u32 v4, v6, 5, v4
    s_lshl_b32 s36, s16, 6
    v_add_u32 v4, s36, v4
    v_lshrrev_b32 v6, 1, v2
    v_lshlrev_b32 v6, 5, v6
    v_lshl_add_u32 v6, v5, 2, v6
    s_lshl_b32 s36, s3, 6
    v_add_u32 v6, s36, v6
    v_mul_u32_u24 v7, 4352, v4
    v_lshl_add_u32 v7, v6, 1, v7
    v_and_b32 v8, 63, v6
    v_mul_u32_u24 v8, 144, v8
    v_and_b32 v9, 63, v4
    v_lshl_add_u32 v8, v9, 1, v8
    v_mul_u32_u24 v9, 96, v4
    v_lshlrev_b32 v10, 1, v4
    v_lshrrev_b32 v5, 3, v0
    v_and_b32 v6, 7, v0
    v_mul_u32_u24 v4, 144, v5
    v_lshl_add_u32 v4, v6, 4, v4
    v_lshlrev_b32 v5, 10, v5
    v_lshl_add_u32 v5, v6, 4, v5
    s_lshl_b32 s36, s3, 16
    s_lshl_b32 s37, s16, 7
    s_add_u32 s36, s36, s37
    s_add_u32 s37, s36, 0x8000
    v_lshlrev_b32 v11, 4, v1
    v_mul_u32_u24 v13, 12288, v2
    v_add_u32 v13, v13, v11
    v_xor_b32 v12, 1, v2
    v_mul_u32_u24 v12, 12288, v12
    v_add_u32 v12, v12, v11
    v_xor_b32 v14, 2, v2
    v_mul_u32_u24 v14, 12288, v14
    v_add_u32 v14, v14, v11
    v_xor_b32 v15, 3, v2
    v_mul_u32_u24 v15, 12288, v15
    v_add_u32 v15, v15, v11

    s_waitcnt vmcnt(18)
    v_mfma_f32_32x32x16_bf16 v[240:255], v[36:39], v[44:47], 0
    v_mfma_f32_32x32x16_bf16 v[224:239], v[36:39], v[40:43], 0
    v_mfma_f32_32x32x16_bf16 v[208:223], v[32:35], v[44:47], 0
    v_mfma_f32_32x32x16_bf16 v[192:207], v[32:35], v[40:43], 0
    s_waitcnt vmcnt(16)
    v_mfma_f32_32x32x16_bf16 v[240:255], v[52:55], v[60:63], v[240:255]
    v_mfma_f32_32x32x16_bf16 v[224:239], v[52:55], v[56:59], v[224:239]
    v_mfma_f32_32x32x16_bf16 v[208:223], v[48:51], v[60:63], v[208:223]
    v_mfma_f32_32x32x16_bf16 v[192:207], v[48:51], v[56:59], v[192:207]
    buffer_load_dwordx4 v[32:35], v28, s[20:23], s38 offen
    buffer_load_dwordx4 v[36:39], v29, s[20:23], s38 offen
    buffer_load_dwordx4 v[40:43], v30, s[40:43], s38 offen
    buffer_load_dwordx4 v[44:47], v31, s[40:43], s38 offen
    s_add_u32 s38, s38, 1024
    s_waitcnt vmcnt(18)
    v_mfma_f32_32x32x16_bf16 v[240:255], v[68:71], v[76:79], v[240:255]
    v_mfma_f32_32x32x16_bf16 v[224:239], v[68:71], v[72:75], v[224:239]
    v_mfma_f32_32x32x16_bf16 v[208:223], v[64:67], v[76:79], v[208:223]
    v_mfma_f32_32x32x16_bf16 v[192:207], v[64:67], v[72:75], v[192:207]
    buffer_load_dwordx4 v[48:51], v28, s[20:23], s38 offen
    buffer_load_dwordx4 v[52:55], v29, s[20:23], s38 offen
    buffer_load_dwordx4 v[56:59], v30, s[40:43], s38 offen
    buffer_load_dwordx4 v[60:63], v31, s[40:43], s38 offen
    s_add_u32 s38, s38, 1024
    s_waitcnt vmcnt(20)
    v_mfma_f32_32x32x16_bf16 v[240:255], v[84:87], v[92:95], v[240:255]
    v_mfma_f32_32x32x16_bf16 v[224:239], v[84:87], v[88:91], v[224:239]
    v_mfma_f32_32x32x16_bf16 v[208:223], v[80:83], v[92:95], v[208:223]
    v_mfma_f32_32x32x16_bf16 v[192:207], v[80:83], v[88:91], v[192:207]
    buffer_load_dwordx4 v[64:67], v28, s[20:23], s38 offen
    buffer_load_dwordx4 v[68:71], v29, s[20:23], s38 offen
    buffer_load_dwordx4 v[72:75], v30, s[40:43], s38 offen
    buffer_load_dwordx4 v[76:79], v31, s[40:43], s38 offen
    s_add_u32 s38, s38, 1024
    s_waitcnt vmcnt(22)
    v_mfma_f32_32x32x16_bf16 v[240:255], v[100:103], v[108:111], v[240:255]
    v_mfma_f32_32x32x16_bf16 v[224:239], v[100:103], v[104:107], v[224:239]
    v_mfma_f32_32x32x16_bf16 v[208:223], v[96:99], v[108:111], v[208:223]
    v_mfma_f32_32x32x16_bf16 v[192:207], v[96:99], v[104:107], v[192:207]
    buffer_load_dwordx4 v[80:83], v28, s[20:23], s38 offen
    buffer_load_dwordx4 v[84:87], v29, s[20:23], s38 offen
    buffer_load_dwordx4 v[88:91], v30, s[40:43], s38 offen
    buffer_load_dwordx4 v[92:95], v31, s[40:43], s38 offen
    s_add_u32 s38, s38, 1024
    s_waitcnt vmcnt(24)
    v_mfma_f32_32x32x16_bf16 v[240:255], v[116:119], v[124:127], v[240:255]
    v_mfma_f32_32x32x16_bf16 v[224:239], v[116:119], v[120:123], v[224:239]
    v_mfma_f32_32x32x16_bf16 v[208:223], v[112:115], v[124:127], v[208:223]
    v_mfma_f32_32x32x16_bf16 v[192:207], v[112:115], v[120:123], v[192:207]
    buffer_load_dwordx4 v[96:99], v28, s[20:23], s38 offen
    buffer_load_dwordx4 v[100:103], v29, s[20:23], s38 offen
    buffer_load_dwordx4 v[104:107], v30, s[40:43], s38 offen
    buffer_load_dwordx4 v[108:111], v31, s[40:43], s38 offen
    s_add_u32 s38, s38, 1024
    s_waitcnt vmcnt(26)
    v_mfma_f32_32x32x16_bf16 v[240:255], v[132:135], v[140:143], v[240:255]
    v_mfma_f32_32x32x16_bf16 v[224:239], v[132:135], v[136:139], v[224:239]
    v_mfma_f32_32x32x16_bf16 v[208:223], v[128:131], v[140:143], v[208:223]
    v_mfma_f32_32x32x16_bf16 v[192:207], v[128:131], v[136:139], v[192:207]
    buffer_load_dwordx4 v[112:115], v28, s[20:23], s38 offen
    buffer_load_dwordx4 v[116:119], v29, s[20:23], s38 offen
    buffer_load_dwordx4 v[120:123], v30, s[40:43], s38 offen
    buffer_load_dwordx4 v[124:127], v31, s[40:43], s38 offen
    s_add_u32 s38, s38, 1024
    s_waitcnt vmcnt(28)
    v_mfma_f32_32x32x16_bf16 v[240:255], v[148:151], v[156:159], v[240:255]
    v_mfma_f32_32x32x16_bf16 v[224:239], v[148:151], v[152:155], v[224:239]
    v_mfma_f32_32x32x16_bf16 v[208:223], v[144:147], v[156:159], v[208:223]
    v_mfma_f32_32x32x16_bf16 v[192:207], v[144:147], v[152:155], v[192:207]
    buffer_load_dwordx4 v[128:131], v28, s[20:23], s38 offen
    buffer_load_dwordx4 v[132:135], v29, s[20:23], s38 offen
    buffer_load_dwordx4 v[136:139], v30, s[40:43], s38 offen
    buffer_load_dwordx4 v[140:143], v31, s[40:43], s38 offen
    s_add_u32 s38, s38, 1024
    s_waitcnt vmcnt(30)
    v_mfma_f32_32x32x16_bf16 v[240:255], v[164:167], v[172:175], v[240:255]
    v_mfma_f32_32x32x16_bf16 v[224:239], v[164:167], v[168:171], v[224:239]
    v_mfma_f32_32x32x16_bf16 v[208:223], v[160:163], v[172:175], v[208:223]
    v_mfma_f32_32x32x16_bf16 v[192:207], v[160:163], v[168:171], v[192:207]
    buffer_load_dwordx4 v[144:147], v28, s[20:23], s38 offen
    buffer_load_dwordx4 v[148:151], v29, s[20:23], s38 offen
    buffer_load_dwordx4 v[152:155], v30, s[40:43], s38 offen
    buffer_load_dwordx4 v[156:159], v31, s[40:43], s38 offen
    s_add_u32 s38, s38, 1024
    s_waitcnt vmcnt(32)
    v_mfma_f32_32x32x16_bf16 v[240:255], v[180:183], v[188:191], v[240:255]
    v_mfma_f32_32x32x16_bf16 v[224:239], v[180:183], v[184:187], v[224:239]
    v_mfma_f32_32x32x16_bf16 v[208:223], v[176:179], v[188:191], v[208:223]
    v_mfma_f32_32x32x16_bf16 v[192:207], v[176:179], v[184:187], v[192:207]
    buffer_load_dwordx4 v[160:163], v28, s[20:23], s38 offen
    buffer_load_dwordx4 v[164:167], v29, s[20:23], s38 offen
    buffer_load_dwordx4 v[168:171], v30, s[40:43], s38 offen
    buffer_load_dwordx4 v[172:175], v31, s[40:43], s38 offen
    s_add_u32 s38, s38, 1024
    s_waitcnt vmcnt(32)
    v_mfma_f32_32x32x16_bf16 v[240:255], v[36:39], v[44:47], v[240:255]
    v_mfma_f32_32x32x16_bf16 v[224:239], v[36:39], v[40:43], v[224:239]
    v_mfma_f32_32x32x16_bf16 v[208:223], v[32:35], v[44:47], v[208:223]
    v_mfma_f32_32x32x16_bf16 v[192:207], v[32:35], v[40:43], v[192:207]
    buffer_load_dwordx4 v[176:179], v28, s[20:23], s38 offen
    buffer_load_dwordx4 v[180:183], v29, s[20:23], s38 offen
    buffer_load_dwordx4 v[184:187], v30, s[40:43], s38 offen
    buffer_load_dwordx4 v[188:191], v31, s[40:43], s38 offen
    s_add_u32 s38, s38, 1024
    s_waitcnt vmcnt(32)
    v_mfma_f32_32x32x16_bf16 v[240:255], v[52:55], v[60:63], v[240:255]
    v_mfma_f32_32x32x16_bf16 v[224:239], v[52:55], v[56:59], v[224:239]
    v_mfma_f32_32x32x16_bf16 v[208:223], v[48:51], v[60:63], v[208:223]
    v_mfma_f32_32x32x16_bf16 v[192:207], v[48:51], v[56:59], v[192:207]
    buffer_load_dwordx4 v[32:35], v28, s[20:23], s38 offen
    buffer_load_dwordx4 v[36:39], v29, s[20:23], s38 offen
    buffer_load_dwordx4 v[40:43], v30, s[40:43], s38 offen
    buffer_load_dwordx4 v[44:47], v31, s[40:43], s38 offen
    s_add_u32 s38, s38, 1024
    s_waitcnt vmcnt(32)
    v_mfma_f32_32x32x16_bf16 v[240:255], v[68:71], v[76:79], v[240:255]
    v_mfma_f32_32x32x16_bf16 v[224:239], v[68:71], v[72:75], v[224:239]
    v_mfma_f32_32x32x16_bf16 v[208:223], v[64:67], v[76:79], v[208:223]
    v_mfma_f32_32x32x16_bf16 v[192:207], v[64:67], v[72:75], v[192:207]
    buffer_load_dwordx4 v[48:51], v28, s[20:23], s38 offen
    buffer_load_dwordx4 v[52:55], v29, s[20:23], s38 offen
    buffer_load_dwordx4 v[56:59], v30, s[40:43], s38 offen
    buffer_load_dwordx4 v[60:63], v31, s[40:43], s38 offen
    s_add_u32 s38, s38, 1024
    s_waitcnt vmcnt(32)
    v_mfma_f32_32x32x16_bf16 v[240:255], v[84:87], v[92:95], v[240:255]
    v_mfma_f32_32x32x16_bf16 v[224:239], v[84:87], v[88:91], v[224:239]
    v_mfma_f32_32x32x16_bf16 v[208:223], v[80:83], v[92:95], v[208:223]
    v_mfma_f32_32x32x16_bf16 v[192:207], v[80:83], v[88:91], v[192:207]
    buffer_load_dwordx4 v[64:67], v28, s[20:23], s38 offen
    buffer_load_dwordx4 v[68:71], v29, s[20:23], s38 offen
    buffer_load_dwordx4 v[72:75], v30, s[40:43], s38 offen
    buffer_load_dwordx4 v[76:79], v31, s[40:43], s38 offen
    s_add_u32 s38, s38, 1024
    s_waitcnt vmcnt(32)
    v_mfma_f32_32x32x16_bf16 v[240:255], v[100:103], v[108:111], v[240:255]
    v_mfma_f32_32x32x16_bf16 v[224:239], v[100:103], v[104:107], v[224:239]
    v_mfma_f32_32x32x16_bf16 v[208:223], v[96:99], v[108:111], v[208:223]
    v_mfma_f32_32x32x16_bf16 v[192:207], v[96:99], v[104:107], v[192:207]
    buffer_load_dwordx4 v[80:83], v28, s[20:23], s38 offen
    buffer_load_dwordx4 v[84:87], v29, s[20:23], s38 offen
    buffer_load_dwordx4 v[88:91], v30, s[40:43], s38 offen
    buffer_load_dwordx4 v[92:95], v31, s[40:43], s38 offen
    s_add_u32 s38, s38, 1024
    s_waitcnt vmcnt(32)
    v_mfma_f32_32x32x16_bf16 v[240:255], v[116:119], v[124:127], v[240:255]
    v_mfma_f32_32x32x16_bf16 v[224:239], v[116:119], v[120:123], v[224:239]
    v_mfma_f32_32x32x16_bf16 v[208:223], v[112:115], v[124:127], v[208:223]
    v_mfma_f32_32x32x16_bf16 v[192:207], v[112:115], v[120:123], v[192:207]
    buffer_load_dwordx4 v[96:99], v28, s[20:23], s38 offen
    buffer_load_dwordx4 v[100:103], v29, s[20:23], s38 offen
    buffer_load_dwordx4 v[104:107], v30, s[40:43], s38 offen
    buffer_load_dwordx4 v[108:111], v31, s[40:43], s38 offen
    s_add_u32 s38, s38, 1024
    s_waitcnt vmcnt(32)
    v_mfma_f32_32x32x16_bf16 v[240:255], v[132:135], v[140:143], v[240:255]
    v_mfma_f32_32x32x16_bf16 v[224:239], v[132:135], v[136:139], v[224:239]
    v_mfma_f32_32x32x16_bf16 v[208:223], v[128:131], v[140:143], v[208:223]
    v_mfma_f32_32x32x16_bf16 v[192:207], v[128:131], v[136:139], v[192:207]
    buffer_load_dwordx4 v[112:115], v28, s[20:23], s38 offen
    buffer_load_dwordx4 v[116:119], v29, s[20:23], s38 offen
    buffer_load_dwordx4 v[120:123], v30, s[40:43], s38 offen
    buffer_load_dwordx4 v[124:127], v31, s[40:43], s38 offen
    s_add_u32 s38, s38, 1024
    s_waitcnt vmcnt(32)
    v_mfma_f32_32x32x16_bf16 v[240:255], v[148:151], v[156:159], v[240:255]
    v_mfma_f32_32x32x16_bf16 v[224:239], v[148:151], v[152:155], v[224:239]
    v_mfma_f32_32x32x16_bf16 v[208:223], v[144:147], v[156:159], v[208:223]
    v_mfma_f32_32x32x16_bf16 v[192:207], v[144:147], v[152:155], v[192:207]
    buffer_load_dwordx4 v[128:131], v28, s[20:23], s38 offen
    buffer_load_dwordx4 v[132:135], v29, s[20:23], s38 offen
    buffer_load_dwordx4 v[136:139], v30, s[40:43], s38 offen
    buffer_load_dwordx4 v[140:143], v31, s[40:43], s38 offen
    s_add_u32 s38, s38, 1024
    buffer_load_dwordx2 v[16:17], v7, s[4:7], 0 offen offset:0
    buffer_load_dwordx2 v[18:19], v7, s[4:7], 0 offen offset:16
    buffer_load_dwordx2 v[20:21], v7, s[4:7], 0 offen offset:32
    buffer_load_dwordx2 v[22:23], v7, s[4:7], 0 offen offset:48
    buffer_load_dwordx4 v[24:27], v9, s[44:47], 0 offen offset:80
    buffer_load_ushort v3, v10, s[48:51], 0 offen
    s_waitcnt vmcnt(38)
    v_mfma_f32_32x32x16_bf16 v[240:255], v[164:167], v[172:175], v[240:255]
    v_mfma_f32_32x32x16_bf16 v[224:239], v[164:167], v[168:171], v[224:239]
    v_mfma_f32_32x32x16_bf16 v[208:223], v[160:163], v[172:175], v[208:223]
    v_mfma_f32_32x32x16_bf16 v[192:207], v[160:163], v[168:171], v[192:207]
    buffer_load_dwordx4 v[144:147], v28, s[20:23], s38 offen
    buffer_load_dwordx4 v[148:151], v29, s[20:23], s38 offen
    buffer_load_dwordx4 v[152:155], v30, s[40:43], s38 offen
    buffer_load_dwordx4 v[156:159], v31, s[40:43], s38 offen
    s_add_u32 s38, s38, 1024
    s_waitcnt vmcnt(38)
    v_mfma_f32_32x32x16_bf16 v[240:255], v[180:183], v[188:191], v[240:255]
    v_mfma_f32_32x32x16_bf16 v[224:239], v[180:183], v[184:187], v[224:239]
    v_mfma_f32_32x32x16_bf16 v[208:223], v[176:179], v[188:191], v[208:223]
    v_mfma_f32_32x32x16_bf16 v[192:207], v[176:179], v[184:187], v[192:207]
    s_waitcnt vmcnt(34)
    v_mfma_f32_32x32x16_bf16 v[240:255], v[36:39], v[44:47], v[240:255]
    v_mfma_f32_32x32x16_bf16 v[224:239], v[36:39], v[40:43], v[224:239]
    v_mfma_f32_32x32x16_bf16 v[208:223], v[32:35], v[44:47], v[208:223]
    v_mfma_f32_32x32x16_bf16 v[192:207], v[32:35], v[40:43], v[192:207]
    s_waitcnt vmcnt(30)
    v_mfma_f32_32x32x16_bf16 v[240:255], v[52:55], v[60:63], v[240:255]
    v_mfma_f32_32x32x16_bf16 v[224:239], v[52:55], v[56:59], v[224:239]
    v_mfma_f32_32x32x16_bf16 v[208:223], v[48:51], v[60:63], v[208:223]
    v_mfma_f32_32x32x16_bf16 v[192:207], v[48:51], v[56:59], v[192:207]
    s_waitcnt vmcnt(26)
    v_mfma_f32_32x32x16_bf16 v[240:255], v[68:71], v[76:79], v[240:255]
    v_mfma_f32_32x32x16_bf16 v[224:239], v[68:71], v[72:75], v[224:239]
    v_mfma_f32_32x32x16_bf16 v[208:223], v[64:67], v[76:79], v[208:223]
    v_mfma_f32_32x32x16_bf16 v[192:207], v[64:67], v[72:75], v[192:207]
    s_waitcnt vmcnt(22)
    v_mfma_f32_32x32x16_bf16 v[240:255], v[84:87], v[92:95], v[240:255]
    v_mfma_f32_32x32x16_bf16 v[224:239], v[84:87], v[88:91], v[224:239]
    v_mfma_f32_32x32x16_bf16 v[208:223], v[80:83], v[92:95], v[208:223]
    v_mfma_f32_32x32x16_bf16 v[192:207], v[80:83], v[88:91], v[192:207]
    s_waitcnt vmcnt(18)
    v_mfma_f32_32x32x16_bf16 v[240:255], v[100:103], v[108:111], v[240:255]
    v_mfma_f32_32x32x16_bf16 v[224:239], v[100:103], v[104:107], v[224:239]
    v_mfma_f32_32x32x16_bf16 v[208:223], v[96:99], v[108:111], v[208:223]
    v_mfma_f32_32x32x16_bf16 v[192:207], v[96:99], v[104:107], v[192:207]
    s_waitcnt vmcnt(14)
    v_mfma_f32_32x32x16_bf16 v[240:255], v[116:119], v[124:127], v[240:255]
    v_mfma_f32_32x32x16_bf16 v[224:239], v[116:119], v[120:123], v[224:239]
    v_mfma_f32_32x32x16_bf16 v[208:223], v[112:115], v[124:127], v[208:223]
    v_mfma_f32_32x32x16_bf16 v[192:207], v[112:115], v[120:123], v[192:207]
    s_waitcnt vmcnt(10)
    v_mfma_f32_32x32x16_bf16 v[240:255], v[132:135], v[140:143], v[240:255]
    v_mfma_f32_32x32x16_bf16 v[224:239], v[132:135], v[136:139], v[224:239]
    v_mfma_f32_32x32x16_bf16 v[208:223], v[128:131], v[140:143], v[208:223]
    v_mfma_f32_32x32x16_bf16 v[192:207], v[128:131], v[136:139], v[192:207]
    s_waitcnt vmcnt(0)
    v_mfma_f32_32x32x16_bf16 v[240:255], v[148:151], v[156:159], v[240:255]
    v_mfma_f32_32x32x16_bf16 v[224:239], v[148:151], v[152:155], v[224:239]
    v_mfma_f32_32x32x16_bf16 v[208:223], v[144:147], v[156:159], v[208:223]
    v_mfma_f32_32x32x16_bf16 v[192:207], v[144:147], v[152:155], v[192:207]
    s_nop 9
    ds_write_b128 v15, v[240:243] offset:8192
    ds_write_b128 v15, v[244:247] offset:9216
    ds_write_b128 v15, v[248:251] offset:10240
    ds_write_b128 v15, v[252:255] offset:11264
    ds_write_b128 v14, v[224:227] offset:4096
    ds_write_b128 v14, v[228:231] offset:5120
    ds_write_b128 v14, v[232:235] offset:6144
    ds_write_b128 v14, v[236:239] offset:7168
    ds_write_b128 v12, v[208:211] offset:0
    ds_write_b128 v12, v[212:215] offset:1024
    ds_write_b128 v12, v[216:219] offset:2048
    ds_write_b128 v12, v[220:223] offset:3072
    v_add_f32 v24, v24, v25
    v_add_f32 v26, v26, v27
    v_add_f32 v24, v24, v26
    v_cvt_pk_bf16_f32 v24, v24, v24
    v_lshlrev_b32 v24, 16, v24
    v_lshlrev_b32 v28, 16, v3

    v_mov_b32 v32, v192
    v_mov_b32 v33, v193
    v_mov_b32 v34, v194
    v_mov_b32 v35, v195
    v_mov_b32 v36, v196
    v_mov_b32 v37, v197
    v_mov_b32 v38, v198
    v_mov_b32 v39, v199
    v_mov_b32 v40, v200
    v_mov_b32 v41, v201
    v_mov_b32 v42, v202
    v_mov_b32 v43, v203
    v_mov_b32 v44, v204
    v_mov_b32 v45, v205
    v_mov_b32 v46, v206
    v_mov_b32 v47, v207
    v_lshlrev_b32 v96, 16, v16
    v_and_b32 v97, s17, v16
    v_lshlrev_b32 v98, 16, v17
    v_and_b32 v99, s17, v17
    v_lshlrev_b32 v100, 16, v18
    v_and_b32 v101, s17, v18
    v_lshlrev_b32 v102, 16, v19
    v_and_b32 v103, s17, v19
    v_lshlrev_b32 v104, 16, v20
    v_and_b32 v105, s17, v20
    v_lshlrev_b32 v106, 16, v21
    v_and_b32 v107, s17, v21
    v_lshlrev_b32 v108, 16, v22
    v_and_b32 v109, s17, v22
    v_lshlrev_b32 v110, 16, v23
    v_and_b32 v111, s17, v23
    s_waitcnt lgkmcnt(0)
    s_barrier
    ds_read_b128 v[48:51], v13 offset:0
    ds_read_b128 v[52:55], v13 offset:1024
    ds_read_b128 v[56:59], v13 offset:2048
    ds_read_b128 v[60:63], v13 offset:3072
    ds_read_b128 v[64:67], v13 offset:4096
    ds_read_b128 v[68:71], v13 offset:5120
    ds_read_b128 v[72:75], v13 offset:6144
    ds_read_b128 v[76:79], v13 offset:7168
    ds_read_b128 v[80:83], v13 offset:8192
    ds_read_b128 v[84:87], v13 offset:9216
    ds_read_b128 v[88:91], v13 offset:10240
    ds_read_b128 v[92:95], v13 offset:11264
    s_waitcnt lgkmcnt(8)
    v_pk_add_f32 v[32:33], v[32:33], v[48:49]
    v_pk_add_f32 v[34:35], v[34:35], v[50:51]
    v_pk_add_f32 v[36:37], v[36:37], v[52:53]
    v_pk_add_f32 v[38:39], v[38:39], v[54:55]
    v_pk_add_f32 v[40:41], v[40:41], v[56:57]
    v_pk_add_f32 v[42:43], v[42:43], v[58:59]
    v_pk_add_f32 v[44:45], v[44:45], v[60:61]
    v_pk_add_f32 v[46:47], v[46:47], v[62:63]
    s_waitcnt lgkmcnt(4)
    v_pk_add_f32 v[32:33], v[32:33], v[64:65]
    v_pk_add_f32 v[34:35], v[34:35], v[66:67]
    v_pk_add_f32 v[36:37], v[36:37], v[68:69]
    v_pk_add_f32 v[38:39], v[38:39], v[70:71]
    v_pk_add_f32 v[40:41], v[40:41], v[72:73]
    v_pk_add_f32 v[42:43], v[42:43], v[74:75]
    v_pk_add_f32 v[44:45], v[44:45], v[76:77]
    v_pk_add_f32 v[46:47], v[46:47], v[78:79]
    s_waitcnt lgkmcnt(0)
    v_pk_add_f32 v[32:33], v[32:33], v[80:81]
    v_pk_add_f32 v[34:35], v[34:35], v[82:83]
    v_pk_add_f32 v[36:37], v[36:37], v[84:85]
    v_pk_add_f32 v[38:39], v[38:39], v[86:87]
    v_pk_add_f32 v[40:41], v[40:41], v[88:89]
    v_pk_add_f32 v[42:43], v[42:43], v[90:91]
    v_pk_add_f32 v[44:45], v[44:45], v[92:93]
    v_pk_add_f32 v[46:47], v[46:47], v[94:95]
    v_cvt_pk_bf16_f32 v32, v32, v33
    v_cvt_pk_bf16_f32 v34, v34, v35
    v_cvt_pk_bf16_f32 v36, v36, v37
    v_cvt_pk_bf16_f32 v38, v38, v39
    v_cvt_pk_bf16_f32 v40, v40, v41
    v_cvt_pk_bf16_f32 v42, v42, v43
    v_cvt_pk_bf16_f32 v44, v44, v45
    v_cvt_pk_bf16_f32 v46, v46, v47
    v_and_b32 v33, s17, v32
    v_lshlrev_b32 v32, 16, v32
    v_and_b32 v35, s17, v34
    v_lshlrev_b32 v34, 16, v34
    v_and_b32 v37, s17, v36
    v_lshlrev_b32 v36, 16, v36
    v_and_b32 v39, s17, v38
    v_lshlrev_b32 v38, 16, v38
    v_and_b32 v41, s17, v40
    v_lshlrev_b32 v40, 16, v40
    v_and_b32 v43, s17, v42
    v_lshlrev_b32 v42, 16, v42
    v_and_b32 v45, s17, v44
    v_lshlrev_b32 v44, 16, v44
    v_and_b32 v47, s17, v46
    v_lshlrev_b32 v46, 16, v46
    v_pk_add_f32 v[32:33], v[32:33], v[28:29] op_sel_hi:[1,0]
    v_pk_add_f32 v[34:35], v[34:35], v[28:29] op_sel_hi:[1,0]
    v_pk_add_f32 v[36:37], v[36:37], v[28:29] op_sel_hi:[1,0]
    v_pk_add_f32 v[38:39], v[38:39], v[28:29] op_sel_hi:[1,0]
    v_pk_add_f32 v[40:41], v[40:41], v[28:29] op_sel_hi:[1,0]
    v_pk_add_f32 v[42:43], v[42:43], v[28:29] op_sel_hi:[1,0]
    v_pk_add_f32 v[44:45], v[44:45], v[28:29] op_sel_hi:[1,0]
    v_pk_add_f32 v[46:47], v[46:47], v[28:29] op_sel_hi:[1,0]
    v_cvt_pk_bf16_f32 v32, v32, v33
    v_cvt_pk_bf16_f32 v34, v34, v35
    v_cvt_pk_bf16_f32 v36, v36, v37
    v_cvt_pk_bf16_f32 v38, v38, v39
    v_cvt_pk_bf16_f32 v40, v40, v41
    v_cvt_pk_bf16_f32 v42, v42, v43
    v_cvt_pk_bf16_f32 v44, v44, v45
    v_cvt_pk_bf16_f32 v46, v46, v47
    v_and_b32 v33, s17, v32
    v_lshlrev_b32 v32, 16, v32
    v_and_b32 v35, s17, v34
    v_lshlrev_b32 v34, 16, v34
    v_and_b32 v37, s17, v36
    v_lshlrev_b32 v36, 16, v36
    v_and_b32 v39, s17, v38
    v_lshlrev_b32 v38, 16, v38
    v_and_b32 v41, s17, v40
    v_lshlrev_b32 v40, 16, v40
    v_and_b32 v43, s17, v42
    v_lshlrev_b32 v42, 16, v42
    v_and_b32 v45, s17, v44
    v_lshlrev_b32 v44, 16, v44
    v_and_b32 v47, s17, v46
    v_lshlrev_b32 v46, 16, v46
    v_pk_mul_f32 v[32:33], v[32:33], v[24:25] op_sel_hi:[1,0]
    v_pk_mul_f32 v[34:35], v[34:35], v[24:25] op_sel_hi:[1,0]
    v_pk_mul_f32 v[36:37], v[36:37], v[24:25] op_sel_hi:[1,0]
    v_pk_mul_f32 v[38:39], v[38:39], v[24:25] op_sel_hi:[1,0]
    v_pk_mul_f32 v[40:41], v[40:41], v[24:25] op_sel_hi:[1,0]
    v_pk_mul_f32 v[42:43], v[42:43], v[24:25] op_sel_hi:[1,0]
    v_pk_mul_f32 v[44:45], v[44:45], v[24:25] op_sel_hi:[1,0]
    v_pk_mul_f32 v[46:47], v[46:47], v[24:25] op_sel_hi:[1,0]
    v_cvt_pk_bf16_f32 v32, v32, v33
    v_cvt_pk_bf16_f32 v34, v34, v35
    v_cvt_pk_bf16_f32 v36, v36, v37
    v_cvt_pk_bf16_f32 v38, v38, v39
    v_cvt_pk_bf16_f32 v40, v40, v41
    v_cvt_pk_bf16_f32 v42, v42, v43
    v_cvt_pk_bf16_f32 v44, v44, v45
    v_cvt_pk_bf16_f32 v46, v46, v47
    v_and_b32 v33, s17, v32
    v_lshlrev_b32 v32, 16, v32
    v_and_b32 v35, s17, v34
    v_lshlrev_b32 v34, 16, v34
    v_and_b32 v37, s17, v36
    v_lshlrev_b32 v36, 16, v36
    v_and_b32 v39, s17, v38
    v_lshlrev_b32 v38, 16, v38
    v_and_b32 v41, s17, v40
    v_lshlrev_b32 v40, 16, v40
    v_and_b32 v43, s17, v42
    v_lshlrev_b32 v42, 16, v42
    v_and_b32 v45, s17, v44
    v_lshlrev_b32 v44, 16, v44
    v_and_b32 v47, s17, v46
    v_lshlrev_b32 v46, 16, v46
    v_pk_add_f32 v[32:33], v[32:33], v[96:97]
    v_pk_add_f32 v[34:35], v[34:35], v[98:99]
    v_pk_add_f32 v[36:37], v[36:37], v[100:101]
    v_pk_add_f32 v[38:39], v[38:39], v[102:103]
    v_pk_add_f32 v[40:41], v[40:41], v[104:105]
    v_pk_add_f32 v[42:43], v[42:43], v[106:107]
    v_pk_add_f32 v[44:45], v[44:45], v[108:109]
    v_pk_add_f32 v[46:47], v[46:47], v[110:111]
    v_cvt_pk_bf16_f32 v48, v32, v33
    v_cvt_pk_bf16_f32 v49, v34, v35
    v_cvt_pk_bf16_f32 v50, v36, v37
    v_cvt_pk_bf16_f32 v51, v38, v39
    v_cvt_pk_bf16_f32 v52, v40, v41
    v_cvt_pk_bf16_f32 v53, v42, v43
    v_cvt_pk_bf16_f32 v54, v44, v45
    v_cvt_pk_bf16_f32 v55, v46, v47
    ds_write_b16 v8, v48 offset:49152
    ds_write_b16_d16_hi v8, v48 offset:49296
    ds_write_b16 v8, v49 offset:49440
    ds_write_b16_d16_hi v8, v49 offset:49584
    ds_write_b16 v8, v50 offset:50304
    ds_write_b16_d16_hi v8, v50 offset:50448
    ds_write_b16 v8, v51 offset:50592
    ds_write_b16_d16_hi v8, v51 offset:50736
    ds_write_b16 v8, v52 offset:51456
    ds_write_b16_d16_hi v8, v52 offset:51600
    ds_write_b16 v8, v53 offset:51744
    ds_write_b16_d16_hi v8, v53 offset:51888
    ds_write_b16 v8, v54 offset:52608
    ds_write_b16_d16_hi v8, v54 offset:52752
    ds_write_b16 v8, v55 offset:52896
    ds_write_b16_d16_hi v8, v55 offset:53040
    s_waitcnt lgkmcnt(0)
    s_barrier
    ds_read_b128 v[32:35], v4 offset:49152
    ds_read_b128 v[36:39], v4 offset:53760
    s_waitcnt lgkmcnt(1)
    buffer_store_dwordx4 v[32:35], v5, s[52:55], s36 offen sc0 sc1
    s_waitcnt lgkmcnt(0)
    buffer_store_dwordx4 v[36:39], v5, s[52:55], s37 offen sc0 sc1
K4_END:
    s_endpgm
K3_ST:
    v_mov_b32 v12, 0x3f803f80
    v_mov_b32 v16, 0
    v_mov_b32 v17, 0
    v_mov_b32 v18, 0
    v_mov_b32 v19, 0
    v_mov_b32 v20, 0
    v_mov_b32 v21, 0
    v_mov_b32 v22, 0
    v_mov_b32 v23, 0
    s_add_u32 m0, s25, 0
    s_mul_i32 s28, s29, 278528
    s_add_u32 s28, s28, s19
    buffer_load_dwordx4 v4, s[4:7], s28 offen lds
    s_add_u32 s29, s29, 1
    s_and_b32 s29, s29, 7
    s_add_u32 m0, s25, 8192
    s_mul_i32 s28, s29, 278528
    s_add_u32 s28, s28, s19
    buffer_load_dwordx4 v4, s[4:7], s28 offen lds
    s_add_u32 s29, s29, 1
    s_and_b32 s29, s29, 7
    s_add_u32 m0, s25, 16384
    s_mul_i32 s28, s29, 278528
    s_add_u32 s28, s28, s19
    buffer_load_dwordx4 v4, s[4:7], s28 offen lds
    s_add_u32 s29, s29, 1
    s_and_b32 s29, s29, 7
    s_waitcnt vmcnt(2)
    s_barrier
    ds_read_b64_tr_b16 v[24:25], v10 offset:0
    ds_read_b64_tr_b16 v[26:27], v10 offset:512
    ds_read_b64_tr_b16 v[28:29], v11 offset:0
    ds_read_b64_tr_b16 v[30:31], v11 offset:512
    ds_read_b64_tr_b16 v[32:33], v10 offset:2048
    ds_read_b64_tr_b16 v[34:35], v10 offset:2560
    ds_read_b64_tr_b16 v[36:37], v11 offset:2048
    ds_read_b64_tr_b16 v[38:39], v11 offset:2560
    ds_read_b64_tr_b16 v[40:41], v10 offset:4096
    ds_read_b64_tr_b16 v[42:43], v10 offset:4608
    ds_read_b64_tr_b16 v[44:45], v11 offset:4096
    ds_read_b64_tr_b16 v[46:47], v11 offset:4608
    ds_read_b64_tr_b16 v[48:49], v10 offset:6144
    ds_read_b64_tr_b16 v[50:51], v10 offset:6656
    ds_read_b64_tr_b16 v[52:53], v11 offset:6144
    ds_read_b64_tr_b16 v[54:55], v11 offset:6656
    s_waitcnt lgkmcnt(12)
    v_dot2c_f32_bf16 v16, v24, v12
    v_dot2c_f32_bf16 v17, v24, v24
    v_dot2c_f32_bf16 v20, v28, v12
    v_dot2c_f32_bf16 v21, v28, v28
    v_dot2c_f32_bf16 v18, v25, v12
    v_dot2c_f32_bf16 v19, v25, v25
    v_dot2c_f32_bf16 v22, v29, v12
    v_dot2c_f32_bf16 v23, v29, v29
    v_dot2c_f32_bf16 v16, v26, v12
    v_dot2c_f32_bf16 v17, v26, v26
    v_dot2c_f32_bf16 v20, v30, v12
    v_dot2c_f32_bf16 v21, v30, v30
    v_dot2c_f32_bf16 v18, v27, v12
    v_dot2c_f32_bf16 v19, v27, v27
    v_dot2c_f32_bf16 v22, v31, v12
    v_dot2c_f32_bf16 v23, v31, v31
    s_waitcnt lgkmcnt(8)
    v_dot2c_f32_bf16 v16, v32, v12
    v_dot2c_f32_bf16 v17, v32, v32
    v_dot2c_f32_bf16 v20, v36, v12
    v_dot2c_f32_bf16 v21, v36, v36
    v_dot2c_f32_bf16 v18, v33, v12
    v_dot2c_f32_bf16 v19, v33, v33
    v_dot2c_f32_bf16 v22, v37, v12
    v_dot2c_f32_bf16 v23, v37, v37
    v_dot2c_f32_bf16 v16, v34, v12
    v_dot2c_f32_bf16 v17, v34, v34
    v_dot2c_f32_bf16 v20, v38, v12
    v_dot2c_f32_bf16 v21, v38, v38
    v_dot2c_f32_bf16 v18, v35, v12
    v_dot2c_f32_bf16 v19, v35, v35
    v_dot2c_f32_bf16 v22, v39, v12
    v_dot2c_f32_bf16 v23, v39, v39
    s_waitcnt lgkmcnt(4)
    v_dot2c_f32_bf16 v16, v40, v12
    v_dot2c_f32_bf16 v17, v40, v40
    v_dot2c_f32_bf16 v20, v44, v12
    v_dot2c_f32_bf16 v21, v44, v44
    v_dot2c_f32_bf16 v18, v41, v12
    v_dot2c_f32_bf16 v19, v41, v41
    v_dot2c_f32_bf16 v22, v45, v12
    v_dot2c_f32_bf16 v23, v45, v45
    v_dot2c_f32_bf16 v16, v42, v12
    v_dot2c_f32_bf16 v17, v42, v42
    v_dot2c_f32_bf16 v20, v46, v12
    v_dot2c_f32_bf16 v21, v46, v46
    v_dot2c_f32_bf16 v18, v43, v12
    v_dot2c_f32_bf16 v19, v43, v43
    v_dot2c_f32_bf16 v22, v47, v12
    v_dot2c_f32_bf16 v23, v47, v47
    s_waitcnt lgkmcnt(0)
    v_dot2c_f32_bf16 v16, v48, v12
    v_dot2c_f32_bf16 v17, v48, v48
    v_dot2c_f32_bf16 v20, v52, v12
    v_dot2c_f32_bf16 v21, v52, v52
    v_dot2c_f32_bf16 v18, v49, v12
    v_dot2c_f32_bf16 v19, v49, v49
    v_dot2c_f32_bf16 v22, v53, v12
    v_dot2c_f32_bf16 v23, v53, v53
    v_dot2c_f32_bf16 v16, v50, v12
    v_dot2c_f32_bf16 v17, v50, v50
    v_dot2c_f32_bf16 v20, v54, v12
    v_dot2c_f32_bf16 v21, v54, v54
    v_dot2c_f32_bf16 v18, v51, v12
    v_dot2c_f32_bf16 v19, v51, v51
    v_dot2c_f32_bf16 v22, v55, v12
    v_dot2c_f32_bf16 v23, v55, v55
    s_add_u32 m0, s25, 24576
    s_mul_i32 s28, s29, 278528
    s_add_u32 s28, s28, s19
    buffer_load_dwordx4 v4, s[4:7], s28 offen lds
    s_add_u32 s29, s29, 1
    s_and_b32 s29, s29, 7
    s_waitcnt vmcnt(2)
    s_barrier
    ds_read_b64_tr_b16 v[24:25], v10 offset:8192
    ds_read_b64_tr_b16 v[26:27], v10 offset:8704
    ds_read_b64_tr_b16 v[28:29], v11 offset:8192
    ds_read_b64_tr_b16 v[30:31], v11 offset:8704
    ds_read_b64_tr_b16 v[32:33], v10 offset:10240
    ds_read_b64_tr_b16 v[34:35], v10 offset:10752
    ds_read_b64_tr_b16 v[36:37], v11 offset:10240
    ds_read_b64_tr_b16 v[38:39], v11 offset:10752
    ds_read_b64_tr_b16 v[40:41], v10 offset:12288
    ds_read_b64_tr_b16 v[42:43], v10 offset:12800
    ds_read_b64_tr_b16 v[44:45], v11 offset:12288
    ds_read_b64_tr_b16 v[46:47], v11 offset:12800
    ds_read_b64_tr_b16 v[48:49], v10 offset:14336
    ds_read_b64_tr_b16 v[50:51], v10 offset:14848
    ds_read_b64_tr_b16 v[52:53], v11 offset:14336
    ds_read_b64_tr_b16 v[54:55], v11 offset:14848
    s_waitcnt lgkmcnt(12)
    v_dot2c_f32_bf16 v16, v24, v12
    v_dot2c_f32_bf16 v17, v24, v24
    v_dot2c_f32_bf16 v20, v28, v12
    v_dot2c_f32_bf16 v21, v28, v28
    v_dot2c_f32_bf16 v18, v25, v12
    v_dot2c_f32_bf16 v19, v25, v25
    v_dot2c_f32_bf16 v22, v29, v12
    v_dot2c_f32_bf16 v23, v29, v29
    v_dot2c_f32_bf16 v16, v26, v12
    v_dot2c_f32_bf16 v17, v26, v26
    v_dot2c_f32_bf16 v20, v30, v12
    v_dot2c_f32_bf16 v21, v30, v30
    v_dot2c_f32_bf16 v18, v27, v12
    v_dot2c_f32_bf16 v19, v27, v27
    v_dot2c_f32_bf16 v22, v31, v12
    v_dot2c_f32_bf16 v23, v31, v31
    s_waitcnt lgkmcnt(8)
    v_dot2c_f32_bf16 v16, v32, v12
    v_dot2c_f32_bf16 v17, v32, v32
    v_dot2c_f32_bf16 v20, v36, v12
    v_dot2c_f32_bf16 v21, v36, v36
    v_dot2c_f32_bf16 v18, v33, v12
    v_dot2c_f32_bf16 v19, v33, v33
    v_dot2c_f32_bf16 v22, v37, v12
    v_dot2c_f32_bf16 v23, v37, v37
    v_dot2c_f32_bf16 v16, v34, v12
    v_dot2c_f32_bf16 v17, v34, v34
    v_dot2c_f32_bf16 v20, v38, v12
    v_dot2c_f32_bf16 v21, v38, v38
    v_dot2c_f32_bf16 v18, v35, v12
    v_dot2c_f32_bf16 v19, v35, v35
    v_dot2c_f32_bf16 v22, v39, v12
    v_dot2c_f32_bf16 v23, v39, v39
    s_waitcnt lgkmcnt(4)
    v_dot2c_f32_bf16 v16, v40, v12
    v_dot2c_f32_bf16 v17, v40, v40
    v_dot2c_f32_bf16 v20, v44, v12
    v_dot2c_f32_bf16 v21, v44, v44
    v_dot2c_f32_bf16 v18, v41, v12
    v_dot2c_f32_bf16 v19, v41, v41
    v_dot2c_f32_bf16 v22, v45, v12
    v_dot2c_f32_bf16 v23, v45, v45
    v_dot2c_f32_bf16 v16, v42, v12
    v_dot2c_f32_bf16 v17, v42, v42
    v_dot2c_f32_bf16 v20, v46, v12
    v_dot2c_f32_bf16 v21, v46, v46
    v_dot2c_f32_bf16 v18, v43, v12
    v_dot2c_f32_bf16 v19, v43, v43
    v_dot2c_f32_bf16 v22, v47, v12
    v_dot2c_f32_bf16 v23, v47, v47
    s_waitcnt lgkmcnt(0)
    v_dot2c_f32_bf16 v16, v48, v12
    v_dot2c_f32_bf16 v17, v48, v48
    v_dot2c_f32_bf16 v20, v52, v12
    v_dot2c_f32_bf16 v21, v52, v52
    v_dot2c_f32_bf16 v18, v49, v12
    v_dot2c_f32_bf16 v19, v49, v49
    v_dot2c_f32_bf16 v22, v53, v12
    v_dot2c_f32_bf16 v23, v53, v53
    v_dot2c_f32_bf16 v16, v50, v12
    v_dot2c_f32_bf16 v17, v50, v50
    v_dot2c_f32_bf16 v20, v54, v12
    v_dot2c_f32_bf16 v21, v54, v54
    v_dot2c_f32_bf16 v18, v51, v12
    v_dot2c_f32_bf16 v19, v51, v51
    v_dot2c_f32_bf16 v22, v55, v12
    v_dot2c_f32_bf16 v23, v55, v55
    s_add_u32 m0, s25, 32768
    s_mul_i32 s28, s29, 278528
    s_add_u32 s28, s28, s19
    buffer_load_dwordx4 v4, s[4:7], s28 offen lds
    s_add_u32 s29, s29, 1
    s_and_b32 s29, s29, 7
    s_waitcnt vmcnt(2)
    s_barrier
    ds_read_b64_tr_b16 v[24:25], v10 offset:16384
    ds_read_b64_tr_b16 v[26:27], v10 offset:16896
    ds_read_b64_tr_b16 v[28:29], v11 offset:16384
    ds_read_b64_tr_b16 v[30:31], v11 offset:16896
    ds_read_b64_tr_b16 v[32:33], v10 offset:18432
    ds_read_b64_tr_b16 v[34:35], v10 offset:18944
    ds_read_b64_tr_b16 v[36:37], v11 offset:18432
    ds_read_b64_tr_b16 v[38:39], v11 offset:18944
    ds_read_b64_tr_b16 v[40:41], v10 offset:20480
    ds_read_b64_tr_b16 v[42:43], v10 offset:20992
    ds_read_b64_tr_b16 v[44:45], v11 offset:20480
    ds_read_b64_tr_b16 v[46:47], v11 offset:20992
    ds_read_b64_tr_b16 v[48:49], v10 offset:22528
    ds_read_b64_tr_b16 v[50:51], v10 offset:23040
    ds_read_b64_tr_b16 v[52:53], v11 offset:22528
    ds_read_b64_tr_b16 v[54:55], v11 offset:23040
    s_waitcnt lgkmcnt(12)
    v_dot2c_f32_bf16 v16, v24, v12
    v_dot2c_f32_bf16 v17, v24, v24
    v_dot2c_f32_bf16 v20, v28, v12
    v_dot2c_f32_bf16 v21, v28, v28
    v_dot2c_f32_bf16 v18, v25, v12
    v_dot2c_f32_bf16 v19, v25, v25
    v_dot2c_f32_bf16 v22, v29, v12
    v_dot2c_f32_bf16 v23, v29, v29
    v_dot2c_f32_bf16 v16, v26, v12
    v_dot2c_f32_bf16 v17, v26, v26
    v_dot2c_f32_bf16 v20, v30, v12
    v_dot2c_f32_bf16 v21, v30, v30
    v_dot2c_f32_bf16 v18, v27, v12
    v_dot2c_f32_bf16 v19, v27, v27
    v_dot2c_f32_bf16 v22, v31, v12
    v_dot2c_f32_bf16 v23, v31, v31
    s_waitcnt lgkmcnt(8)
    v_dot2c_f32_bf16 v16, v32, v12
    v_dot2c_f32_bf16 v17, v32, v32
    v_dot2c_f32_bf16 v20, v36, v12
    v_dot2c_f32_bf16 v21, v36, v36
    v_dot2c_f32_bf16 v18, v33, v12
    v_dot2c_f32_bf16 v19, v33, v33
    v_dot2c_f32_bf16 v22, v37, v12
    v_dot2c_f32_bf16 v23, v37, v37
    v_dot2c_f32_bf16 v16, v34, v12
    v_dot2c_f32_bf16 v17, v34, v34
    v_dot2c_f32_bf16 v20, v38, v12
    v_dot2c_f32_bf16 v21, v38, v38
    v_dot2c_f32_bf16 v18, v35, v12
    v_dot2c_f32_bf16 v19, v35, v35
    v_dot2c_f32_bf16 v22, v39, v12
    v_dot2c_f32_bf16 v23, v39, v39
    s_waitcnt lgkmcnt(4)
    v_dot2c_f32_bf16 v16, v40, v12
    v_dot2c_f32_bf16 v17, v40, v40
    v_dot2c_f32_bf16 v20, v44, v12
    v_dot2c_f32_bf16 v21, v44, v44
    v_dot2c_f32_bf16 v18, v41, v12
    v_dot2c_f32_bf16 v19, v41, v41
    v_dot2c_f32_bf16 v22, v45, v12
    v_dot2c_f32_bf16 v23, v45, v45
    v_dot2c_f32_bf16 v16, v42, v12
    v_dot2c_f32_bf16 v17, v42, v42
    v_dot2c_f32_bf16 v20, v46, v12
    v_dot2c_f32_bf16 v21, v46, v46
    v_dot2c_f32_bf16 v18, v43, v12
    v_dot2c_f32_bf16 v19, v43, v43
    v_dot2c_f32_bf16 v22, v47, v12
    v_dot2c_f32_bf16 v23, v47, v47
    s_waitcnt lgkmcnt(0)
    v_dot2c_f32_bf16 v16, v48, v12
    v_dot2c_f32_bf16 v17, v48, v48
    v_dot2c_f32_bf16 v20, v52, v12
    v_dot2c_f32_bf16 v21, v52, v52
    v_dot2c_f32_bf16 v18, v49, v12
    v_dot2c_f32_bf16 v19, v49, v49
    v_dot2c_f32_bf16 v22, v53, v12
    v_dot2c_f32_bf16 v23, v53, v53
    v_dot2c_f32_bf16 v16, v50, v12
    v_dot2c_f32_bf16 v17, v50, v50
    v_dot2c_f32_bf16 v20, v54, v12
    v_dot2c_f32_bf16 v21, v54, v54
    v_dot2c_f32_bf16 v18, v51, v12
    v_dot2c_f32_bf16 v19, v51, v51
    v_dot2c_f32_bf16 v22, v55, v12
    v_dot2c_f32_bf16 v23, v55, v55
    s_add_u32 m0, s25, 40960
    s_mul_i32 s28, s29, 278528
    s_add_u32 s28, s28, s19
    buffer_load_dwordx4 v4, s[4:7], s28 offen lds
    s_add_u32 s29, s29, 1
    s_and_b32 s29, s29, 7
    s_waitcnt vmcnt(2)
    s_barrier
    ds_read_b64_tr_b16 v[24:25], v10 offset:24576
    ds_read_b64_tr_b16 v[26:27], v10 offset:25088
    ds_read_b64_tr_b16 v[28:29], v11 offset:24576
    ds_read_b64_tr_b16 v[30:31], v11 offset:25088
    ds_read_b64_tr_b16 v[32:33], v10 offset:26624
    ds_read_b64_tr_b16 v[34:35], v10 offset:27136
    ds_read_b64_tr_b16 v[36:37], v11 offset:26624
    ds_read_b64_tr_b16 v[38:39], v11 offset:27136
    ds_read_b64_tr_b16 v[40:41], v10 offset:28672
    ds_read_b64_tr_b16 v[42:43], v10 offset:29184
    ds_read_b64_tr_b16 v[44:45], v11 offset:28672
    ds_read_b64_tr_b16 v[46:47], v11 offset:29184
    ds_read_b64_tr_b16 v[48:49], v10 offset:30720
    ds_read_b64_tr_b16 v[50:51], v10 offset:31232
    ds_read_b64_tr_b16 v[52:53], v11 offset:30720
    ds_read_b64_tr_b16 v[54:55], v11 offset:31232
    s_waitcnt lgkmcnt(12)
    v_dot2c_f32_bf16 v16, v24, v12
    v_dot2c_f32_bf16 v17, v24, v24
    v_dot2c_f32_bf16 v20, v28, v12
    v_dot2c_f32_bf16 v21, v28, v28
    v_dot2c_f32_bf16 v18, v25, v12
    v_dot2c_f32_bf16 v19, v25, v25
    v_dot2c_f32_bf16 v22, v29, v12
    v_dot2c_f32_bf16 v23, v29, v29
    v_dot2c_f32_bf16 v16, v26, v12
    v_dot2c_f32_bf16 v17, v26, v26
    v_dot2c_f32_bf16 v20, v30, v12
    v_dot2c_f32_bf16 v21, v30, v30
    v_dot2c_f32_bf16 v18, v27, v12
    v_dot2c_f32_bf16 v19, v27, v27
    v_dot2c_f32_bf16 v22, v31, v12
    v_dot2c_f32_bf16 v23, v31, v31
    s_waitcnt lgkmcnt(8)
    v_dot2c_f32_bf16 v16, v32, v12
    v_dot2c_f32_bf16 v17, v32, v32
    v_dot2c_f32_bf16 v20, v36, v12
    v_dot2c_f32_bf16 v21, v36, v36
    v_dot2c_f32_bf16 v18, v33, v12
    v_dot2c_f32_bf16 v19, v33, v33
    v_dot2c_f32_bf16 v22, v37, v12
    v_dot2c_f32_bf16 v23, v37, v37
    v_dot2c_f32_bf16 v16, v34, v12
    v_dot2c_f32_bf16 v17, v34, v34
    v_dot2c_f32_bf16 v20, v38, v12
    v_dot2c_f32_bf16 v21, v38, v38
    v_dot2c_f32_bf16 v18, v35, v12
    v_dot2c_f32_bf16 v19, v35, v35
    v_dot2c_f32_bf16 v22, v39, v12
    v_dot2c_f32_bf16 v23, v39, v39
    s_waitcnt lgkmcnt(4)
    v_dot2c_f32_bf16 v16, v40, v12
    v_dot2c_f32_bf16 v17, v40, v40
    v_dot2c_f32_bf16 v20, v44, v12
    v_dot2c_f32_bf16 v21, v44, v44
    v_dot2c_f32_bf16 v18, v41, v12
    v_dot2c_f32_bf16 v19, v41, v41
    v_dot2c_f32_bf16 v22, v45, v12
    v_dot2c_f32_bf16 v23, v45, v45
    v_dot2c_f32_bf16 v16, v42, v12
    v_dot2c_f32_bf16 v17, v42, v42
    v_dot2c_f32_bf16 v20, v46, v12
    v_dot2c_f32_bf16 v21, v46, v46
    v_dot2c_f32_bf16 v18, v43, v12
    v_dot2c_f32_bf16 v19, v43, v43
    v_dot2c_f32_bf16 v22, v47, v12
    v_dot2c_f32_bf16 v23, v47, v47
    s_waitcnt lgkmcnt(0)
    v_dot2c_f32_bf16 v16, v48, v12
    v_dot2c_f32_bf16 v17, v48, v48
    v_dot2c_f32_bf16 v20, v52, v12
    v_dot2c_f32_bf16 v21, v52, v52
    v_dot2c_f32_bf16 v18, v49, v12
    v_dot2c_f32_bf16 v19, v49, v49
    v_dot2c_f32_bf16 v22, v53, v12
    v_dot2c_f32_bf16 v23, v53, v53
    v_dot2c_f32_bf16 v16, v50, v12
    v_dot2c_f32_bf16 v17, v50, v50
    v_dot2c_f32_bf16 v20, v54, v12
    v_dot2c_f32_bf16 v21, v54, v54
    v_dot2c_f32_bf16 v18, v51, v12
    v_dot2c_f32_bf16 v19, v51, v51
    v_dot2c_f32_bf16 v22, v55, v12
    v_dot2c_f32_bf16 v23, v55, v55
    s_add_u32 m0, s25, 49152
    s_mul_i32 s28, s29, 278528
    s_add_u32 s28, s28, s19
    buffer_load_dwordx4 v4, s[4:7], s28 offen lds
    s_add_u32 s29, s29, 1
    s_and_b32 s29, s29, 7
    s_waitcnt vmcnt(2)
    s_barrier
    ds_read_b64_tr_b16 v[24:25], v10 offset:32768
    ds_read_b64_tr_b16 v[26:27], v10 offset:33280
    ds_read_b64_tr_b16 v[28:29], v11 offset:32768
    ds_read_b64_tr_b16 v[30:31], v11 offset:33280
    ds_read_b64_tr_b16 v[32:33], v10 offset:34816
    ds_read_b64_tr_b16 v[34:35], v10 offset:35328
    ds_read_b64_tr_b16 v[36:37], v11 offset:34816
    ds_read_b64_tr_b16 v[38:39], v11 offset:35328
    ds_read_b64_tr_b16 v[40:41], v10 offset:36864
    ds_read_b64_tr_b16 v[42:43], v10 offset:37376
    ds_read_b64_tr_b16 v[44:45], v11 offset:36864
    ds_read_b64_tr_b16 v[46:47], v11 offset:37376
    ds_read_b64_tr_b16 v[48:49], v10 offset:38912
    ds_read_b64_tr_b16 v[50:51], v10 offset:39424
    ds_read_b64_tr_b16 v[52:53], v11 offset:38912
    ds_read_b64_tr_b16 v[54:55], v11 offset:39424
    s_waitcnt lgkmcnt(12)
    v_dot2c_f32_bf16 v16, v24, v12
    v_dot2c_f32_bf16 v17, v24, v24
    v_dot2c_f32_bf16 v20, v28, v12
    v_dot2c_f32_bf16 v21, v28, v28
    v_dot2c_f32_bf16 v18, v25, v12
    v_dot2c_f32_bf16 v19, v25, v25
    v_dot2c_f32_bf16 v22, v29, v12
    v_dot2c_f32_bf16 v23, v29, v29
    v_dot2c_f32_bf16 v16, v26, v12
    v_dot2c_f32_bf16 v17, v26, v26
    v_dot2c_f32_bf16 v20, v30, v12
    v_dot2c_f32_bf16 v21, v30, v30
    v_dot2c_f32_bf16 v18, v27, v12
    v_dot2c_f32_bf16 v19, v27, v27
    v_dot2c_f32_bf16 v22, v31, v12
    v_dot2c_f32_bf16 v23, v31, v31
    s_waitcnt lgkmcnt(8)
    v_dot2c_f32_bf16 v16, v32, v12
    v_dot2c_f32_bf16 v17, v32, v32
    v_dot2c_f32_bf16 v20, v36, v12
    v_dot2c_f32_bf16 v21, v36, v36
    v_dot2c_f32_bf16 v18, v33, v12
    v_dot2c_f32_bf16 v19, v33, v33
    v_dot2c_f32_bf16 v22, v37, v12
    v_dot2c_f32_bf16 v23, v37, v37
    v_dot2c_f32_bf16 v16, v34, v12
    v_dot2c_f32_bf16 v17, v34, v34
    v_dot2c_f32_bf16 v20, v38, v12
    v_dot2c_f32_bf16 v21, v38, v38
    v_dot2c_f32_bf16 v18, v35, v12
    v_dot2c_f32_bf16 v19, v35, v35
    v_dot2c_f32_bf16 v22, v39, v12
    v_dot2c_f32_bf16 v23, v39, v39
    s_waitcnt lgkmcnt(4)
    v_dot2c_f32_bf16 v16, v40, v12
    v_dot2c_f32_bf16 v17, v40, v40
    v_dot2c_f32_bf16 v20, v44, v12
    v_dot2c_f32_bf16 v21, v44, v44
    v_dot2c_f32_bf16 v18, v41, v12
    v_dot2c_f32_bf16 v19, v41, v41
    v_dot2c_f32_bf16 v22, v45, v12
    v_dot2c_f32_bf16 v23, v45, v45
    v_dot2c_f32_bf16 v16, v42, v12
    v_dot2c_f32_bf16 v17, v42, v42
    v_dot2c_f32_bf16 v20, v46, v12
    v_dot2c_f32_bf16 v21, v46, v46
    v_dot2c_f32_bf16 v18, v43, v12
    v_dot2c_f32_bf16 v19, v43, v43
    v_dot2c_f32_bf16 v22, v47, v12
    v_dot2c_f32_bf16 v23, v47, v47
    s_waitcnt lgkmcnt(0)
    v_dot2c_f32_bf16 v16, v48, v12
    v_dot2c_f32_bf16 v17, v48, v48
    v_dot2c_f32_bf16 v20, v52, v12
    v_dot2c_f32_bf16 v21, v52, v52
    v_dot2c_f32_bf16 v18, v49, v12
    v_dot2c_f32_bf16 v19, v49, v49
    v_dot2c_f32_bf16 v22, v53, v12
    v_dot2c_f32_bf16 v23, v53, v53
    v_dot2c_f32_bf16 v16, v50, v12
    v_dot2c_f32_bf16 v17, v50, v50
    v_dot2c_f32_bf16 v20, v54, v12
    v_dot2c_f32_bf16 v21, v54, v54
    v_dot2c_f32_bf16 v18, v51, v12
    v_dot2c_f32_bf16 v19, v51, v51
    v_dot2c_f32_bf16 v22, v55, v12
    v_dot2c_f32_bf16 v23, v55, v55
    s_add_u32 m0, s25, 57344
    s_mul_i32 s28, s29, 278528
    s_add_u32 s28, s28, s19
    buffer_load_dwordx4 v4, s[4:7], s28 offen lds
    s_add_u32 s29, s29, 1
    s_and_b32 s29, s29, 7
    s_waitcnt vmcnt(2)
    s_barrier
    ds_read_b64_tr_b16 v[24:25], v10 offset:40960
    ds_read_b64_tr_b16 v[26:27], v10 offset:41472
    ds_read_b64_tr_b16 v[28:29], v11 offset:40960
    ds_read_b64_tr_b16 v[30:31], v11 offset:41472
    ds_read_b64_tr_b16 v[32:33], v10 offset:43008
    ds_read_b64_tr_b16 v[34:35], v10 offset:43520
    ds_read_b64_tr_b16 v[36:37], v11 offset:43008
    ds_read_b64_tr_b16 v[38:39], v11 offset:43520
    ds_read_b64_tr_b16 v[40:41], v10 offset:45056
    ds_read_b64_tr_b16 v[42:43], v10 offset:45568
    ds_read_b64_tr_b16 v[44:45], v11 offset:45056
    ds_read_b64_tr_b16 v[46:47], v11 offset:45568
    ds_read_b64_tr_b16 v[48:49], v10 offset:47104
    ds_read_b64_tr_b16 v[50:51], v10 offset:47616
    ds_read_b64_tr_b16 v[52:53], v11 offset:47104
    ds_read_b64_tr_b16 v[54:55], v11 offset:47616
    s_waitcnt lgkmcnt(12)
    v_dot2c_f32_bf16 v16, v24, v12
    v_dot2c_f32_bf16 v17, v24, v24
    v_dot2c_f32_bf16 v20, v28, v12
    v_dot2c_f32_bf16 v21, v28, v28
    v_dot2c_f32_bf16 v18, v25, v12
    v_dot2c_f32_bf16 v19, v25, v25
    v_dot2c_f32_bf16 v22, v29, v12
    v_dot2c_f32_bf16 v23, v29, v29
    v_dot2c_f32_bf16 v16, v26, v12
    v_dot2c_f32_bf16 v17, v26, v26
    v_dot2c_f32_bf16 v20, v30, v12
    v_dot2c_f32_bf16 v21, v30, v30
    v_dot2c_f32_bf16 v18, v27, v12
    v_dot2c_f32_bf16 v19, v27, v27
    v_dot2c_f32_bf16 v22, v31, v12
    v_dot2c_f32_bf16 v23, v31, v31
    s_waitcnt lgkmcnt(8)
    v_dot2c_f32_bf16 v16, v32, v12
    v_dot2c_f32_bf16 v17, v32, v32
    v_dot2c_f32_bf16 v20, v36, v12
    v_dot2c_f32_bf16 v21, v36, v36
    v_dot2c_f32_bf16 v18, v33, v12
    v_dot2c_f32_bf16 v19, v33, v33
    v_dot2c_f32_bf16 v22, v37, v12
    v_dot2c_f32_bf16 v23, v37, v37
    v_dot2c_f32_bf16 v16, v34, v12
    v_dot2c_f32_bf16 v17, v34, v34
    v_dot2c_f32_bf16 v20, v38, v12
    v_dot2c_f32_bf16 v21, v38, v38
    v_dot2c_f32_bf16 v18, v35, v12
    v_dot2c_f32_bf16 v19, v35, v35
    v_dot2c_f32_bf16 v22, v39, v12
    v_dot2c_f32_bf16 v23, v39, v39
    s_waitcnt lgkmcnt(4)
    v_dot2c_f32_bf16 v16, v40, v12
    v_dot2c_f32_bf16 v17, v40, v40
    v_dot2c_f32_bf16 v20, v44, v12
    v_dot2c_f32_bf16 v21, v44, v44
    v_dot2c_f32_bf16 v18, v41, v12
    v_dot2c_f32_bf16 v19, v41, v41
    v_dot2c_f32_bf16 v22, v45, v12
    v_dot2c_f32_bf16 v23, v45, v45
    v_dot2c_f32_bf16 v16, v42, v12
    v_dot2c_f32_bf16 v17, v42, v42
    v_dot2c_f32_bf16 v20, v46, v12
    v_dot2c_f32_bf16 v21, v46, v46
    v_dot2c_f32_bf16 v18, v43, v12
    v_dot2c_f32_bf16 v19, v43, v43
    v_dot2c_f32_bf16 v22, v47, v12
    v_dot2c_f32_bf16 v23, v47, v47
    s_waitcnt lgkmcnt(0)
    v_dot2c_f32_bf16 v16, v48, v12
    v_dot2c_f32_bf16 v17, v48, v48
    v_dot2c_f32_bf16 v20, v52, v12
    v_dot2c_f32_bf16 v21, v52, v52
    v_dot2c_f32_bf16 v18, v49, v12
    v_dot2c_f32_bf16 v19, v49, v49
    v_dot2c_f32_bf16 v22, v53, v12
    v_dot2c_f32_bf16 v23, v53, v53
    v_dot2c_f32_bf16 v16, v50, v12
    v_dot2c_f32_bf16 v17, v50, v50
    v_dot2c_f32_bf16 v20, v54, v12
    v_dot2c_f32_bf16 v21, v54, v54
    v_dot2c_f32_bf16 v18, v51, v12
    v_dot2c_f32_bf16 v19, v51, v51
    v_dot2c_f32_bf16 v22, v55, v12
    v_dot2c_f32_bf16 v23, v55, v55
    s_waitcnt vmcnt(1)
    s_barrier
    ds_read_b64_tr_b16 v[24:25], v10 offset:49152
    ds_read_b64_tr_b16 v[26:27], v10 offset:49664
    ds_read_b64_tr_b16 v[28:29], v11 offset:49152
    ds_read_b64_tr_b16 v[30:31], v11 offset:49664
    ds_read_b64_tr_b16 v[32:33], v10 offset:51200
    ds_read_b64_tr_b16 v[34:35], v10 offset:51712
    ds_read_b64_tr_b16 v[36:37], v11 offset:51200
    ds_read_b64_tr_b16 v[38:39], v11 offset:51712
    ds_read_b64_tr_b16 v[40:41], v10 offset:53248
    ds_read_b64_tr_b16 v[42:43], v10 offset:53760
    ds_read_b64_tr_b16 v[44:45], v11 offset:53248
    ds_read_b64_tr_b16 v[46:47], v11 offset:53760
    ds_read_b64_tr_b16 v[48:49], v10 offset:55296
    ds_read_b64_tr_b16 v[50:51], v10 offset:55808
    ds_read_b64_tr_b16 v[52:53], v11 offset:55296
    ds_read_b64_tr_b16 v[54:55], v11 offset:55808
    s_waitcnt lgkmcnt(12)
    v_dot2c_f32_bf16 v16, v24, v12
    v_dot2c_f32_bf16 v17, v24, v24
    v_dot2c_f32_bf16 v20, v28, v12
    v_dot2c_f32_bf16 v21, v28, v28
    v_dot2c_f32_bf16 v18, v25, v12
    v_dot2c_f32_bf16 v19, v25, v25
    v_dot2c_f32_bf16 v22, v29, v12
    v_dot2c_f32_bf16 v23, v29, v29
    v_dot2c_f32_bf16 v16, v26, v12
    v_dot2c_f32_bf16 v17, v26, v26
    v_dot2c_f32_bf16 v20, v30, v12
    v_dot2c_f32_bf16 v21, v30, v30
    v_dot2c_f32_bf16 v18, v27, v12
    v_dot2c_f32_bf16 v19, v27, v27
    v_dot2c_f32_bf16 v22, v31, v12
    v_dot2c_f32_bf16 v23, v31, v31
    s_waitcnt lgkmcnt(8)
    v_dot2c_f32_bf16 v16, v32, v12
    v_dot2c_f32_bf16 v17, v32, v32
    v_dot2c_f32_bf16 v20, v36, v12
    v_dot2c_f32_bf16 v21, v36, v36
    v_dot2c_f32_bf16 v18, v33, v12
    v_dot2c_f32_bf16 v19, v33, v33
    v_dot2c_f32_bf16 v22, v37, v12
    v_dot2c_f32_bf16 v23, v37, v37
    v_dot2c_f32_bf16 v16, v34, v12
    v_dot2c_f32_bf16 v17, v34, v34
    v_dot2c_f32_bf16 v20, v38, v12
    v_dot2c_f32_bf16 v21, v38, v38
    v_dot2c_f32_bf16 v18, v35, v12
    v_dot2c_f32_bf16 v19, v35, v35
    v_dot2c_f32_bf16 v22, v39, v12
    v_dot2c_f32_bf16 v23, v39, v39
    s_waitcnt lgkmcnt(4)
    v_dot2c_f32_bf16 v16, v40, v12
    v_dot2c_f32_bf16 v17, v40, v40
    v_dot2c_f32_bf16 v20, v44, v12
    v_dot2c_f32_bf16 v21, v44, v44
    v_dot2c_f32_bf16 v18, v41, v12
    v_dot2c_f32_bf16 v19, v41, v41
    v_dot2c_f32_bf16 v22, v45, v12
    v_dot2c_f32_bf16 v23, v45, v45
    v_dot2c_f32_bf16 v16, v42, v12
    v_dot2c_f32_bf16 v17, v42, v42
    v_dot2c_f32_bf16 v20, v46, v12
    v_dot2c_f32_bf16 v21, v46, v46
    v_dot2c_f32_bf16 v18, v43, v12
    v_dot2c_f32_bf16 v19, v43, v43
    v_dot2c_f32_bf16 v22, v47, v12
    v_dot2c_f32_bf16 v23, v47, v47
    s_waitcnt lgkmcnt(0)
    v_dot2c_f32_bf16 v16, v48, v12
    v_dot2c_f32_bf16 v17, v48, v48
    v_dot2c_f32_bf16 v20, v52, v12
    v_dot2c_f32_bf16 v21, v52, v52
    v_dot2c_f32_bf16 v18, v49, v12
    v_dot2c_f32_bf16 v19, v49, v49
    v_dot2c_f32_bf16 v22, v53, v12
    v_dot2c_f32_bf16 v23, v53, v53
    v_dot2c_f32_bf16 v16, v50, v12
    v_dot2c_f32_bf16 v17, v50, v50
    v_dot2c_f32_bf16 v20, v54, v12
    v_dot2c_f32_bf16 v21, v54, v54
    v_dot2c_f32_bf16 v18, v51, v12
    v_dot2c_f32_bf16 v19, v51, v51
    v_dot2c_f32_bf16 v22, v55, v12
    v_dot2c_f32_bf16 v23, v55, v55
    s_waitcnt vmcnt(0)
    s_barrier
    ds_read_b64_tr_b16 v[24:25], v10 offset:57344
    ds_read_b64_tr_b16 v[26:27], v10 offset:57856
    ds_read_b64_tr_b16 v[28:29], v11 offset:57344
    ds_read_b64_tr_b16 v[30:31], v11 offset:57856
    ds_read_b64_tr_b16 v[32:33], v10 offset:59392
    ds_read_b64_tr_b16 v[34:35], v10 offset:59904
    ds_read_b64_tr_b16 v[36:37], v11 offset:59392
    ds_read_b64_tr_b16 v[38:39], v11 offset:59904
    ds_read_b64_tr_b16 v[40:41], v10 offset:61440
    ds_read_b64_tr_b16 v[42:43], v10 offset:61952
    ds_read_b64_tr_b16 v[44:45], v11 offset:61440
    ds_read_b64_tr_b16 v[46:47], v11 offset:61952
    ds_read_b64_tr_b16 v[48:49], v10 offset:63488
    ds_read_b64_tr_b16 v[50:51], v10 offset:64000
    ds_read_b64_tr_b16 v[52:53], v11 offset:63488
    ds_read_b64_tr_b16 v[54:55], v11 offset:64000
    s_waitcnt lgkmcnt(12)
    v_dot2c_f32_bf16 v16, v24, v12
    v_dot2c_f32_bf16 v17, v24, v24
    v_dot2c_f32_bf16 v20, v28, v12
    v_dot2c_f32_bf16 v21, v28, v28
    v_dot2c_f32_bf16 v18, v25, v12
    v_dot2c_f32_bf16 v19, v25, v25
    v_dot2c_f32_bf16 v22, v29, v12
    v_dot2c_f32_bf16 v23, v29, v29
    v_dot2c_f32_bf16 v16, v26, v12
    v_dot2c_f32_bf16 v17, v26, v26
    v_dot2c_f32_bf16 v20, v30, v12
    v_dot2c_f32_bf16 v21, v30, v30
    v_dot2c_f32_bf16 v18, v27, v12
    v_dot2c_f32_bf16 v19, v27, v27
    v_dot2c_f32_bf16 v22, v31, v12
    v_dot2c_f32_bf16 v23, v31, v31
    s_waitcnt lgkmcnt(8)
    v_dot2c_f32_bf16 v16, v32, v12
    v_dot2c_f32_bf16 v17, v32, v32
    v_dot2c_f32_bf16 v20, v36, v12
    v_dot2c_f32_bf16 v21, v36, v36
    v_dot2c_f32_bf16 v18, v33, v12
    v_dot2c_f32_bf16 v19, v33, v33
    v_dot2c_f32_bf16 v22, v37, v12
    v_dot2c_f32_bf16 v23, v37, v37
    v_dot2c_f32_bf16 v16, v34, v12
    v_dot2c_f32_bf16 v17, v34, v34
    v_dot2c_f32_bf16 v20, v38, v12
    v_dot2c_f32_bf16 v21, v38, v38
    v_dot2c_f32_bf16 v18, v35, v12
    v_dot2c_f32_bf16 v19, v35, v35
    v_dot2c_f32_bf16 v22, v39, v12
    v_dot2c_f32_bf16 v23, v39, v39
    s_waitcnt lgkmcnt(4)
    v_dot2c_f32_bf16 v16, v40, v12
    v_dot2c_f32_bf16 v17, v40, v40
    v_dot2c_f32_bf16 v20, v44, v12
    v_dot2c_f32_bf16 v21, v44, v44
    v_dot2c_f32_bf16 v18, v41, v12
    v_dot2c_f32_bf16 v19, v41, v41
    v_dot2c_f32_bf16 v22, v45, v12
    v_dot2c_f32_bf16 v23, v45, v45
    v_dot2c_f32_bf16 v16, v42, v12
    v_dot2c_f32_bf16 v17, v42, v42
    v_dot2c_f32_bf16 v20, v46, v12
    v_dot2c_f32_bf16 v21, v46, v46
    v_dot2c_f32_bf16 v18, v43, v12
    v_dot2c_f32_bf16 v19, v43, v43
    v_dot2c_f32_bf16 v22, v47, v12
    v_dot2c_f32_bf16 v23, v47, v47
    s_waitcnt lgkmcnt(0)
    v_dot2c_f32_bf16 v16, v48, v12
    v_dot2c_f32_bf16 v17, v48, v48
    v_dot2c_f32_bf16 v20, v52, v12
    v_dot2c_f32_bf16 v21, v52, v52
    v_dot2c_f32_bf16 v18, v49, v12
    v_dot2c_f32_bf16 v19, v49, v49
    v_dot2c_f32_bf16 v22, v53, v12
    v_dot2c_f32_bf16 v23, v53, v53
    v_dot2c_f32_bf16 v16, v50, v12
    v_dot2c_f32_bf16 v17, v50, v50
    v_dot2c_f32_bf16 v20, v54, v12
    v_dot2c_f32_bf16 v21, v54, v54
    v_dot2c_f32_bf16 v18, v51, v12
    v_dot2c_f32_bf16 v19, v51, v51
    v_dot2c_f32_bf16 v22, v55, v12
    v_dot2c_f32_bf16 v23, v55, v55
    v_lshlrev_b32 v12, 3, v1
    v_add_u32 v12, 0x10000, v12
    s_nop 2
    v_add_f32 v16, v16, v18
    v_add_f32 v17, v17, v19
    v_add_f32 v20, v20, v22
    v_add_f32 v21, v21, v23
    ds_write_b64 v12, v[16:17]
    ds_write_b64 v12, v[20:21] offset:512
    s_waitcnt lgkmcnt(0)
    s_barrier
K3_END:
    s_endpgm

.section .rodata,"a"
.p2align 6
.amdhsa_kernel k1_kernel
  .amdhsa_next_free_vgpr 112
  .amdhsa_next_free_sgpr 96
  .amdhsa_accum_offset 112
  .amdhsa_group_segment_fixed_size 0
  .amdhsa_kernarg_size 152
  .amdhsa_user_sgpr_count 2
  .amdhsa_user_sgpr_kernarg_segment_ptr 1
  .amdhsa_system_sgpr_workgroup_id_x 1
.end_amdhsa_kernel
.p2align 6
.amdhsa_kernel k2_kernel
  .amdhsa_next_free_vgpr 232
  .amdhsa_next_free_sgpr 96
  .amdhsa_accum_offset 232
  .amdhsa_group_segment_fixed_size 0
  .amdhsa_kernarg_size 152
  .amdhsa_user_sgpr_count 2
  .amdhsa_user_sgpr_kernarg_segment_ptr 1
  .amdhsa_system_sgpr_workgroup_id_x 1
.end_amdhsa_kernel
.p2align 6
.amdhsa_kernel k3_kernel
  .amdhsa_next_free_vgpr 256
  .amdhsa_next_free_sgpr 96
  .amdhsa_accum_offset 256
  .amdhsa_group_segment_fixed_size 0
  .amdhsa_kernarg_size 152
  .amdhsa_user_sgpr_count 2
  .amdhsa_user_sgpr_kernarg_segment_ptr 1
  .amdhsa_system_sgpr_workgroup_id_x 1
.end_amdhsa_kernel
```
